```python
import torch

def _softmax(x, axis=-1):
    return torch.softmax(x, dim=axis)
def _gelu(x):
    return torch.nn.functional.gelu(x, approximate="tanh")
def _silu(x):
    return torch.nn.functional.silu(x)
def _sigmoid(x):
    return torch.sigmoid(x)
def _layernorm(x, axis=-1, eps=1e-5):
    m = x.mean(dim=axis, keepdim=True)
    v = x.var(dim=axis, keepdim=True, unbiased=False)
    return (x - m) / torch.sqrt(v + eps)
def _scatter_add(tgt, idx, src, axis=0):
    return tgt.clone().index_add_(axis, idx, src)
def _segment_sum(src, seg, n):
    out = torch.zeros((n,) + src.shape[1:], dtype=src.dtype)
    return out.index_add_(0, seg, src)
def _pad(x, pw):
    flat = tuple(v for pair in reversed(pw) for v in pair)
    return torch.nn.functional.pad(x, flat)

kernel_name = 'gather_scatter__cheap_equivariant_egnn__graph'

def setup_inputs():

    _w = (lambda a: (lambda t: t.to(torch.bfloat16) if t.is_floating_point() else t)(torch.as_tensor(a)))
    N, deg, D, De = 10000, 16, 256, max(0, 1)
    E = N * deg
    return {
        "h": _w((lambda *s: torch.randn(*s, dtype=torch.bfloat16) * 0.2)(N, D)),
        "pos": _w((lambda *s: torch.randn(*s, dtype=torch.bfloat16) * 0.8)(N, 3)),
        "e_attr": _w((lambda *s: torch.randn(*s, dtype=torch.bfloat16) * 0.8)(E, De)),
        "src": _w((lambda lo, hi, *s: torch.randint(lo, hi, s))(0, N, E).to(torch.int64)),
        "dst": _w((lambda lo, hi, *s: torch.randint(lo, hi, s))(0, N, E).to(torch.int64)),
        "w_e": _w(0.1 * (lambda *s: torch.randn(*s, dtype=torch.bfloat16) * 0.8)(2 * D + 1 + De, D)),
        "w_x": _w(0.1 * (lambda *s: torch.randn(*s, dtype=torch.bfloat16) * 0.2)(D, 1)),
        "w_h": _w(0.1 * (lambda *s: torch.randn(*s, dtype=torch.bfloat16) * 0.2)(2 * D, D)),
    }

def reference(h, pos, e_attr, src, dst, w_e, w_x, w_h):
    N, D = h.shape[0], h.shape[1]
    diff = pos[dst] - pos[src]
    dist2 = torch.sum(diff * diff, axis=-1, keepdims=True)
    e_in = torch.concatenate([h[dst], h[src], dist2, e_attr], axis=-1)
    m_ij = _silu(e_in @ w_e)
    coord_scale = m_ij @ w_x
    pos_new = pos + _segment_sum(diff * coord_scale, dst, N)
    m_i = _segment_sum(m_ij, dst, N)
    h_new = h + _silu(torch.concatenate([h, m_i], axis=-1) @ w_h)
    return h_new, pos_new
```

```asm
; @launch kernel=egnn_prep_kernel grid=(801,1,1) block=(256,1,1) lds=69632
; @launch kernel=gather_scatter__cheap_equivariant_egnn__graph_kernel grid=(500,1,1) block=(512,1,1) lds=76800
.amdgcn_target "amdgcn-amd-amdhsa--gfx950"
.text
.globl egnn_prep_kernel
.p2align 8
.type egnn_prep_kernel,@function
egnn_prep_kernel:
    s_load_dwordx16 s[4:19], s[0:1], 0
    s_load_dwordx2 s[20:21], s[0:1], 80
    s_load_dwordx2 s[22:23], s[0:1], 64
    s_cmp_ge_u32 s2, 628
    s_cbranch_scc1 K1_NOTGEMM
    s_waitcnt lgkmcnt(0)
    s_mov_b32 s24, s14
    s_and_b32 s25, s15, 0xffff
    s_mov_b32 s26, 263168
    s_mov_b32 s27, 0x00020000
    s_mov_b32 s28, s4
    s_and_b32 s29, s5, 0xffff
    s_mov_b32 s30, 5120000
    s_mov_b32 s31, 0x00020000
    s_and_b32 s40, s2, 3
    s_lshr_b32 s41, s2, 2
    s_lshr_b32 s42, s40, 1
    s_lshl_b32 s42, s42, 17
    s_and_b32 s43, s40, 1
    s_lshl_b32 s44, s43, 8
    s_add_u32 s42, s42, s44
    v_lshrrev_b32 v1, 4, v0
    v_and_b32 v2, 15, v0
    v_lshlrev_b32 v3, 9, v1
    v_lshl_add_u32 v3, v2, 4, v3
    s_add_u32 s45, s42, 0
    buffer_load_dwordx4 v[8:11], v3, s[24:27], s45 offen
    s_add_u32 s45, s42, 8192
    buffer_load_dwordx4 v[12:15], v3, s[24:27], s45 offen
    s_add_u32 s45, s42, 16384
    buffer_load_dwordx4 v[16:19], v3, s[24:27], s45 offen
    s_add_u32 s45, s42, 24576
    buffer_load_dwordx4 v[20:23], v3, s[24:27], s45 offen
    s_add_u32 s45, s42, 32768
    buffer_load_dwordx4 v[24:27], v3, s[24:27], s45 offen
    s_add_u32 s45, s42, 40960
    buffer_load_dwordx4 v[28:31], v3, s[24:27], s45 offen
    s_add_u32 s45, s42, 49152
    buffer_load_dwordx4 v[32:35], v3, s[24:27], s45 offen
    s_add_u32 s45, s42, 57344
    buffer_load_dwordx4 v[36:39], v3, s[24:27], s45 offen
    s_add_u32 s45, s42, 65536
    buffer_load_dwordx4 v[40:43], v3, s[24:27], s45 offen
    s_add_u32 s45, s42, 73728
    buffer_load_dwordx4 v[44:47], v3, s[24:27], s45 offen
    s_add_u32 s45, s42, 81920
    buffer_load_dwordx4 v[48:51], v3, s[24:27], s45 offen
    s_add_u32 s45, s42, 90112
    buffer_load_dwordx4 v[52:55], v3, s[24:27], s45 offen
    s_add_u32 s45, s42, 98304
    buffer_load_dwordx4 v[56:59], v3, s[24:27], s45 offen
    s_add_u32 s45, s42, 106496
    buffer_load_dwordx4 v[60:63], v3, s[24:27], s45 offen
    s_add_u32 s45, s42, 114688
    buffer_load_dwordx4 v[64:67], v3, s[24:27], s45 offen
    s_add_u32 s45, s42, 122880
    buffer_load_dwordx4 v[68:71], v3, s[24:27], s45 offen
    v_and_b32 v4, 63, v0
    v_lshrrev_b32 v5, 6, v0
    s_lshl_b32 s46, s41, 6
    v_lshlrev_b32 v5, 4, v5
    v_add_u32 v5, s46, v5
    v_and_b32 v6, 15, v4
    v_add_u32 v5, v5, v6
    v_lshrrev_b32 v6, 4, v4
    v_lshlrev_b32 v7, 9, v5
    v_lshl_add_u32 v7, v6, 4, v7
    buffer_load_dwordx4 v[72:75], v7, s[28:31], 0 offen offset:0
    buffer_load_dwordx4 v[76:79], v7, s[28:31], 0 offen offset:64
    buffer_load_dwordx4 v[80:83], v7, s[28:31], 0 offen offset:128
    buffer_load_dwordx4 v[84:87], v7, s[28:31], 0 offen offset:192
    buffer_load_dwordx4 v[88:91], v7, s[28:31], 0 offen offset:256
    buffer_load_dwordx4 v[92:95], v7, s[28:31], 0 offen offset:320
    buffer_load_dwordx4 v[96:99], v7, s[28:31], 0 offen offset:384
    buffer_load_dwordx4 v[100:103], v7, s[28:31], 0 offen offset:448
    v_mul_u32_u24 v104, 272, v1
    v_lshl_add_u32 v104, v2, 4, v104
    s_waitcnt vmcnt(23)
    ds_write_b128 v104, v[8:11] offset:0
    s_waitcnt vmcnt(22)
    ds_write_b128 v104, v[12:15] offset:4352
    s_waitcnt vmcnt(21)
    ds_write_b128 v104, v[16:19] offset:8704
    s_waitcnt vmcnt(20)
    ds_write_b128 v104, v[20:23] offset:13056
    s_waitcnt vmcnt(19)
    ds_write_b128 v104, v[24:27] offset:17408
    s_waitcnt vmcnt(18)
    ds_write_b128 v104, v[28:31] offset:21760
    s_waitcnt vmcnt(17)
    ds_write_b128 v104, v[32:35] offset:26112
    s_waitcnt vmcnt(16)
    ds_write_b128 v104, v[36:39] offset:30464
    s_waitcnt vmcnt(15)
    ds_write_b128 v104, v[40:43] offset:34816
    s_waitcnt vmcnt(14)
    ds_write_b128 v104, v[44:47] offset:39168
    s_waitcnt vmcnt(13)
    ds_write_b128 v104, v[48:51] offset:43520
    s_waitcnt vmcnt(12)
    ds_write_b128 v104, v[52:55] offset:47872
    s_waitcnt vmcnt(11)
    ds_write_b128 v104, v[56:59] offset:52224
    s_waitcnt vmcnt(10)
    ds_write_b128 v104, v[60:63] offset:56576
    s_waitcnt vmcnt(9)
    ds_write_b128 v104, v[64:67] offset:60928
    s_waitcnt vmcnt(8)
    ds_write_b128 v104, v[68:71] offset:65280
    s_add_u32 s32, s20, 8388608
    s_addc_u32 s33, s21, 0
    s_and_b32 s33, s33, 0xffff
    s_mov_b32 s34, 5120000
    s_mov_b32 s35, 0x00020000
    s_mov_b32 s36, s20
    s_and_b32 s37, s21, 0xffff
    s_mov_b32 s38, 5120000
    s_mov_b32 s39, 0x00020000
    v_bfe_u32 v105, v4, 2, 2
    v_lshl_add_u32 v105, v6, 3, v105
    v_mul_u32_u24 v105, 272, v105
    v_and_b32 v106, 3, v4
    v_lshl_add_u32 v105, v106, 3, v105
    v_lshlrev_b32 v106, 10, v5
    v_lshl_add_u32 v106, v6, 4, v106
    v_lshlrev_b32 v107, 9, v5
    v_lshl_add_u32 v107, v6, 3, v107
    s_lshl_b32 s47, s43, 9
    s_lshl_b32 s48, s43, 8
    s_mov_b32 s49, 0xbfb8aa3b
    s_waitcnt lgkmcnt(0)
    s_barrier
    s_waitcnt vmcnt(0)
    ds_read_b64_tr_b16 v[8:9], v105 offset:0
    ds_read_b64_tr_b16 v[10:11], v105 offset:1088
    ds_read_b64_tr_b16 v[12:13], v105 offset:8704
    ds_read_b64_tr_b16 v[14:15], v105 offset:9792
    ds_read_b64_tr_b16 v[16:17], v105 offset:17408
    ds_read_b64_tr_b16 v[18:19], v105 offset:18496
    ds_read_b64_tr_b16 v[20:21], v105 offset:26112
    ds_read_b64_tr_b16 v[22:23], v105 offset:27200
    ds_read_b64_tr_b16 v[24:25], v105 offset:34816
    ds_read_b64_tr_b16 v[26:27], v105 offset:35904
    ds_read_b64_tr_b16 v[28:29], v105 offset:43520
    ds_read_b64_tr_b16 v[30:31], v105 offset:44608
    ds_read_b64_tr_b16 v[32:33], v105 offset:52224
    ds_read_b64_tr_b16 v[34:35], v105 offset:53312
    ds_read_b64_tr_b16 v[36:37], v105 offset:60928
    ds_read_b64_tr_b16 v[38:39], v105 offset:62016
    s_waitcnt lgkmcnt(14)
    v_mfma_f32_16x16x32_bf16 v[40:43], v[8:11], v[72:75], 0
    s_waitcnt lgkmcnt(12)
    v_mfma_f32_16x16x32_bf16 v[40:43], v[12:15], v[76:79], v[40:43]
    s_waitcnt lgkmcnt(10)
    v_mfma_f32_16x16x32_bf16 v[40:43], v[16:19], v[80:83], v[40:43]
    s_waitcnt lgkmcnt(8)
    v_mfma_f32_16x16x32_bf16 v[40:43], v[20:23], v[84:87], v[40:43]
    s_waitcnt lgkmcnt(6)
    v_mfma_f32_16x16x32_bf16 v[40:43], v[24:27], v[88:91], v[40:43]
    s_waitcnt lgkmcnt(4)
    v_mfma_f32_16x16x32_bf16 v[40:43], v[28:31], v[92:95], v[40:43]
    s_waitcnt lgkmcnt(2)
    v_mfma_f32_16x16x32_bf16 v[40:43], v[32:35], v[96:99], v[40:43]
    s_waitcnt lgkmcnt(0)
    v_mfma_f32_16x16x32_bf16 v[40:43], v[36:39], v[100:103], v[40:43]
    s_nop 7
    v_mul_f32 v44, s49, v40
    v_mul_f32 v45, s49, v41
    v_mul_f32 v46, s49, v42
    v_mul_f32 v47, s49, v43
    v_cvt_pk_bf16_f32 v48, v44, v45
    v_cvt_pk_bf16_f32 v49, v46, v47
    s_cmp_ge_u32 s40, 2
    s_cbranch_scc1 K1_STB0
    buffer_store_dwordx2 v[48:49], v107, s[32:35], s48 offen offset:0
    s_branch K1_STD0
K1_STB0:
    buffer_store_dwordx2 v[48:49], v107, s[36:39], s48 offen offset:0
K1_STD0:
    s_nop 1
    ds_read_b64_tr_b16 v[8:9], v105 offset:32
    ds_read_b64_tr_b16 v[10:11], v105 offset:1120
    ds_read_b64_tr_b16 v[12:13], v105 offset:8736
    ds_read_b64_tr_b16 v[14:15], v105 offset:9824
    ds_read_b64_tr_b16 v[16:17], v105 offset:17440
    ds_read_b64_tr_b16 v[18:19], v105 offset:18528
    ds_read_b64_tr_b16 v[20:21], v105 offset:26144
    ds_read_b64_tr_b16 v[22:23], v105 offset:27232
    ds_read_b64_tr_b16 v[24:25], v105 offset:34848
    ds_read_b64_tr_b16 v[26:27], v105 offset:35936
    ds_read_b64_tr_b16 v[28:29], v105 offset:43552
    ds_read_b64_tr_b16 v[30:31], v105 offset:44640
    ds_read_b64_tr_b16 v[32:33], v105 offset:52256
    ds_read_b64_tr_b16 v[34:35], v105 offset:53344
    ds_read_b64_tr_b16 v[36:37], v105 offset:60960
    ds_read_b64_tr_b16 v[38:39], v105 offset:62048
    s_waitcnt lgkmcnt(14)
    v_mfma_f32_16x16x32_bf16 v[40:43], v[8:11], v[72:75], 0
    s_waitcnt lgkmcnt(12)
    v_mfma_f32_16x16x32_bf16 v[40:43], v[12:15], v[76:79], v[40:43]
    s_waitcnt lgkmcnt(10)
    v_mfma_f32_16x16x32_bf16 v[40:43], v[16:19], v[80:83], v[40:43]
    s_waitcnt lgkmcnt(8)
    v_mfma_f32_16x16x32_bf16 v[40:43], v[20:23], v[84:87], v[40:43]
    s_waitcnt lgkmcnt(6)
    v_mfma_f32_16x16x32_bf16 v[40:43], v[24:27], v[88:91], v[40:43]
    s_waitcnt lgkmcnt(4)
    v_mfma_f32_16x16x32_bf16 v[40:43], v[28:31], v[92:95], v[40:43]
    s_waitcnt lgkmcnt(2)
    v_mfma_f32_16x16x32_bf16 v[40:43], v[32:35], v[96:99], v[40:43]
    s_waitcnt lgkmcnt(0)
    v_mfma_f32_16x16x32_bf16 v[40:43], v[36:39], v[100:103], v[40:43]
    s_nop 7
    v_mul_f32 v44, s49, v40
    v_mul_f32 v45, s49, v41
    v_mul_f32 v46, s49, v42
    v_mul_f32 v47, s49, v43
    v_cvt_pk_bf16_f32 v48, v44, v45
    v_cvt_pk_bf16_f32 v49, v46, v47
    s_cmp_ge_u32 s40, 2
    s_cbranch_scc1 K1_STB1
    buffer_store_dwordx2 v[48:49], v107, s[32:35], s48 offen offset:32
    s_branch K1_STD1
K1_STB1:
    buffer_store_dwordx2 v[48:49], v107, s[36:39], s48 offen offset:32
K1_STD1:
    s_nop 1
    ds_read_b64_tr_b16 v[8:9], v105 offset:64
    ds_read_b64_tr_b16 v[10:11], v105 offset:1152
    ds_read_b64_tr_b16 v[12:13], v105 offset:8768
    ds_read_b64_tr_b16 v[14:15], v105 offset:9856
    ds_read_b64_tr_b16 v[16:17], v105 offset:17472
    ds_read_b64_tr_b16 v[18:19], v105 offset:18560
    ds_read_b64_tr_b16 v[20:21], v105 offset:26176
    ds_read_b64_tr_b16 v[22:23], v105 offset:27264
    ds_read_b64_tr_b16 v[24:25], v105 offset:34880
    ds_read_b64_tr_b16 v[26:27], v105 offset:35968
    ds_read_b64_tr_b16 v[28:29], v105 offset:43584
    ds_read_b64_tr_b16 v[30:31], v105 offset:44672
    ds_read_b64_tr_b16 v[32:33], v105 offset:52288
    ds_read_b64_tr_b16 v[34:35], v105 offset:53376
    ds_read_b64_tr_b16 v[36:37], v105 offset:60992
    ds_read_b64_tr_b16 v[38:39], v105 offset:62080
    s_waitcnt lgkmcnt(14)
    v_mfma_f32_16x16x32_bf16 v[40:43], v[8:11], v[72:75], 0
    s_waitcnt lgkmcnt(12)
    v_mfma_f32_16x16x32_bf16 v[40:43], v[12:15], v[76:79], v[40:43]
    s_waitcnt lgkmcnt(10)
    v_mfma_f32_16x16x32_bf16 v[40:43], v[16:19], v[80:83], v[40:43]
    s_waitcnt lgkmcnt(8)
    v_mfma_f32_16x16x32_bf16 v[40:43], v[20:23], v[84:87], v[40:43]
    s_waitcnt lgkmcnt(6)
    v_mfma_f32_16x16x32_bf16 v[40:43], v[24:27], v[88:91], v[40:43]
    s_waitcnt lgkmcnt(4)
    v_mfma_f32_16x16x32_bf16 v[40:43], v[28:31], v[92:95], v[40:43]
    s_waitcnt lgkmcnt(2)
    v_mfma_f32_16x16x32_bf16 v[40:43], v[32:35], v[96:99], v[40:43]
    s_waitcnt lgkmcnt(0)
    v_mfma_f32_16x16x32_bf16 v[40:43], v[36:39], v[100:103], v[40:43]
    s_nop 7
    v_mul_f32 v44, s49, v40
    v_mul_f32 v45, s49, v41
    v_mul_f32 v46, s49, v42
    v_mul_f32 v47, s49, v43
    v_cvt_pk_bf16_f32 v48, v44, v45
    v_cvt_pk_bf16_f32 v49, v46, v47
    s_cmp_ge_u32 s40, 2
    s_cbranch_scc1 K1_STB2
    buffer_store_dwordx2 v[48:49], v107, s[32:35], s48 offen offset:64
    s_branch K1_STD2
K1_STB2:
    buffer_store_dwordx2 v[48:49], v107, s[36:39], s48 offen offset:64
K1_STD2:
    s_nop 1
    ds_read_b64_tr_b16 v[8:9], v105 offset:96
    ds_read_b64_tr_b16 v[10:11], v105 offset:1184
    ds_read_b64_tr_b16 v[12:13], v105 offset:8800
    ds_read_b64_tr_b16 v[14:15], v105 offset:9888
    ds_read_b64_tr_b16 v[16:17], v105 offset:17504
    ds_read_b64_tr_b16 v[18:19], v105 offset:18592
    ds_read_b64_tr_b16 v[20:21], v105 offset:26208
    ds_read_b64_tr_b16 v[22:23], v105 offset:27296
    ds_read_b64_tr_b16 v[24:25], v105 offset:34912
    ds_read_b64_tr_b16 v[26:27], v105 offset:36000
    ds_read_b64_tr_b16 v[28:29], v105 offset:43616
    ds_read_b64_tr_b16 v[30:31], v105 offset:44704
    ds_read_b64_tr_b16 v[32:33], v105 offset:52320
    ds_read_b64_tr_b16 v[34:35], v105 offset:53408
    ds_read_b64_tr_b16 v[36:37], v105 offset:61024
    ds_read_b64_tr_b16 v[38:39], v105 offset:62112
    s_waitcnt lgkmcnt(14)
    v_mfma_f32_16x16x32_bf16 v[40:43], v[8:11], v[72:75], 0
    s_waitcnt lgkmcnt(12)
    v_mfma_f32_16x16x32_bf16 v[40:43], v[12:15], v[76:79], v[40:43]
    s_waitcnt lgkmcnt(10)
    v_mfma_f32_16x16x32_bf16 v[40:43], v[16:19], v[80:83], v[40:43]
    s_waitcnt lgkmcnt(8)
    v_mfma_f32_16x16x32_bf16 v[40:43], v[20:23], v[84:87], v[40:43]
    s_waitcnt lgkmcnt(6)
    v_mfma_f32_16x16x32_bf16 v[40:43], v[24:27], v[88:91], v[40:43]
    s_waitcnt lgkmcnt(4)
    v_mfma_f32_16x16x32_bf16 v[40:43], v[28:31], v[92:95], v[40:43]
    s_waitcnt lgkmcnt(2)
    v_mfma_f32_16x16x32_bf16 v[40:43], v[32:35], v[96:99], v[40:43]
    s_waitcnt lgkmcnt(0)
    v_mfma_f32_16x16x32_bf16 v[40:43], v[36:39], v[100:103], v[40:43]
    s_nop 7
    v_mul_f32 v44, s49, v40
    v_mul_f32 v45, s49, v41
    v_mul_f32 v46, s49, v42
    v_mul_f32 v47, s49, v43
    v_cvt_pk_bf16_f32 v48, v44, v45
    v_cvt_pk_bf16_f32 v49, v46, v47
    s_cmp_ge_u32 s40, 2
    s_cbranch_scc1 K1_STB3
    buffer_store_dwordx2 v[48:49], v107, s[32:35], s48 offen offset:96
    s_branch K1_STD3
K1_STB3:
    buffer_store_dwordx2 v[48:49], v107, s[36:39], s48 offen offset:96
K1_STD3:
    s_nop 1
    ds_read_b64_tr_b16 v[8:9], v105 offset:128
    ds_read_b64_tr_b16 v[10:11], v105 offset:1216
    ds_read_b64_tr_b16 v[12:13], v105 offset:8832
    ds_read_b64_tr_b16 v[14:15], v105 offset:9920
    ds_read_b64_tr_b16 v[16:17], v105 offset:17536
    ds_read_b64_tr_b16 v[18:19], v105 offset:18624
    ds_read_b64_tr_b16 v[20:21], v105 offset:26240
    ds_read_b64_tr_b16 v[22:23], v105 offset:27328
    ds_read_b64_tr_b16 v[24:25], v105 offset:34944
    ds_read_b64_tr_b16 v[26:27], v105 offset:36032
    ds_read_b64_tr_b16 v[28:29], v105 offset:43648
    ds_read_b64_tr_b16 v[30:31], v105 offset:44736
    ds_read_b64_tr_b16 v[32:33], v105 offset:52352
    ds_read_b64_tr_b16 v[34:35], v105 offset:53440
    ds_read_b64_tr_b16 v[36:37], v105 offset:61056
    ds_read_b64_tr_b16 v[38:39], v105 offset:62144
    s_waitcnt lgkmcnt(14)
    v_mfma_f32_16x16x32_bf16 v[40:43], v[8:11], v[72:75], 0
    s_waitcnt lgkmcnt(12)
    v_mfma_f32_16x16x32_bf16 v[40:43], v[12:15], v[76:79], v[40:43]
    s_waitcnt lgkmcnt(10)
    v_mfma_f32_16x16x32_bf16 v[40:43], v[16:19], v[80:83], v[40:43]
    s_waitcnt lgkmcnt(8)
    v_mfma_f32_16x16x32_bf16 v[40:43], v[20:23], v[84:87], v[40:43]
    s_waitcnt lgkmcnt(6)
    v_mfma_f32_16x16x32_bf16 v[40:43], v[24:27], v[88:91], v[40:43]
    s_waitcnt lgkmcnt(4)
    v_mfma_f32_16x16x32_bf16 v[40:43], v[28:31], v[92:95], v[40:43]
    s_waitcnt lgkmcnt(2)
    v_mfma_f32_16x16x32_bf16 v[40:43], v[32:35], v[96:99], v[40:43]
    s_waitcnt lgkmcnt(0)
    v_mfma_f32_16x16x32_bf16 v[40:43], v[36:39], v[100:103], v[40:43]
    s_nop 7
    v_mul_f32 v44, s49, v40
    v_mul_f32 v45, s49, v41
    v_mul_f32 v46, s49, v42
    v_mul_f32 v47, s49, v43
    v_cvt_pk_bf16_f32 v48, v44, v45
    v_cvt_pk_bf16_f32 v49, v46, v47
    s_cmp_ge_u32 s40, 2
    s_cbranch_scc1 K1_STB4
    buffer_store_dwordx2 v[48:49], v107, s[32:35], s48 offen offset:128
    s_branch K1_STD4
K1_STB4:
    buffer_store_dwordx2 v[48:49], v107, s[36:39], s48 offen offset:128
K1_STD4:
    s_nop 1
    ds_read_b64_tr_b16 v[8:9], v105 offset:160
    ds_read_b64_tr_b16 v[10:11], v105 offset:1248
    ds_read_b64_tr_b16 v[12:13], v105 offset:8864
    ds_read_b64_tr_b16 v[14:15], v105 offset:9952
    ds_read_b64_tr_b16 v[16:17], v105 offset:17568
    ds_read_b64_tr_b16 v[18:19], v105 offset:18656
    ds_read_b64_tr_b16 v[20:21], v105 offset:26272
    ds_read_b64_tr_b16 v[22:23], v105 offset:27360
    ds_read_b64_tr_b16 v[24:25], v105 offset:34976
    ds_read_b64_tr_b16 v[26:27], v105 offset:36064
    ds_read_b64_tr_b16 v[28:29], v105 offset:43680
    ds_read_b64_tr_b16 v[30:31], v105 offset:44768
    ds_read_b64_tr_b16 v[32:33], v105 offset:52384
    ds_read_b64_tr_b16 v[34:35], v105 offset:53472
    ds_read_b64_tr_b16 v[36:37], v105 offset:61088
    ds_read_b64_tr_b16 v[38:39], v105 offset:62176
    s_waitcnt lgkmcnt(14)
    v_mfma_f32_16x16x32_bf16 v[40:43], v[8:11], v[72:75], 0
    s_waitcnt lgkmcnt(12)
    v_mfma_f32_16x16x32_bf16 v[40:43], v[12:15], v[76:79], v[40:43]
    s_waitcnt lgkmcnt(10)
    v_mfma_f32_16x16x32_bf16 v[40:43], v[16:19], v[80:83], v[40:43]
    s_waitcnt lgkmcnt(8)
    v_mfma_f32_16x16x32_bf16 v[40:43], v[20:23], v[84:87], v[40:43]
    s_waitcnt lgkmcnt(6)
    v_mfma_f32_16x16x32_bf16 v[40:43], v[24:27], v[88:91], v[40:43]
    s_waitcnt lgkmcnt(4)
    v_mfma_f32_16x16x32_bf16 v[40:43], v[28:31], v[92:95], v[40:43]
    s_waitcnt lgkmcnt(2)
    v_mfma_f32_16x16x32_bf16 v[40:43], v[32:35], v[96:99], v[40:43]
    s_waitcnt lgkmcnt(0)
    v_mfma_f32_16x16x32_bf16 v[40:43], v[36:39], v[100:103], v[40:43]
    s_nop 7
    v_mul_f32 v44, s49, v40
    v_mul_f32 v45, s49, v41
    v_mul_f32 v46, s49, v42
    v_mul_f32 v47, s49, v43
    v_cvt_pk_bf16_f32 v48, v44, v45
    v_cvt_pk_bf16_f32 v49, v46, v47
    s_cmp_ge_u32 s40, 2
    s_cbranch_scc1 K1_STB5
    buffer_store_dwordx2 v[48:49], v107, s[32:35], s48 offen offset:160
    s_branch K1_STD5
K1_STB5:
    buffer_store_dwordx2 v[48:49], v107, s[36:39], s48 offen offset:160
K1_STD5:
    s_nop 1
    ds_read_b64_tr_b16 v[8:9], v105 offset:192
    ds_read_b64_tr_b16 v[10:11], v105 offset:1280
    ds_read_b64_tr_b16 v[12:13], v105 offset:8896
    ds_read_b64_tr_b16 v[14:15], v105 offset:9984
    ds_read_b64_tr_b16 v[16:17], v105 offset:17600
    ds_read_b64_tr_b16 v[18:19], v105 offset:18688
    ds_read_b64_tr_b16 v[20:21], v105 offset:26304
    ds_read_b64_tr_b16 v[22:23], v105 offset:27392
    ds_read_b64_tr_b16 v[24:25], v105 offset:35008
    ds_read_b64_tr_b16 v[26:27], v105 offset:36096
    ds_read_b64_tr_b16 v[28:29], v105 offset:43712
    ds_read_b64_tr_b16 v[30:31], v105 offset:44800
    ds_read_b64_tr_b16 v[32:33], v105 offset:52416
    ds_read_b64_tr_b16 v[34:35], v105 offset:53504
    ds_read_b64_tr_b16 v[36:37], v105 offset:61120
    ds_read_b64_tr_b16 v[38:39], v105 offset:62208
    s_waitcnt lgkmcnt(14)
    v_mfma_f32_16x16x32_bf16 v[40:43], v[8:11], v[72:75], 0
    s_waitcnt lgkmcnt(12)
    v_mfma_f32_16x16x32_bf16 v[40:43], v[12:15], v[76:79], v[40:43]
    s_waitcnt lgkmcnt(10)
    v_mfma_f32_16x16x32_bf16 v[40:43], v[16:19], v[80:83], v[40:43]
    s_waitcnt lgkmcnt(8)
    v_mfma_f32_16x16x32_bf16 v[40:43], v[20:23], v[84:87], v[40:43]
    s_waitcnt lgkmcnt(6)
    v_mfma_f32_16x16x32_bf16 v[40:43], v[24:27], v[88:91], v[40:43]
    s_waitcnt lgkmcnt(4)
    v_mfma_f32_16x16x32_bf16 v[40:43], v[28:31], v[92:95], v[40:43]
    s_waitcnt lgkmcnt(2)
    v_mfma_f32_16x16x32_bf16 v[40:43], v[32:35], v[96:99], v[40:43]
    s_waitcnt lgkmcnt(0)
    v_mfma_f32_16x16x32_bf16 v[40:43], v[36:39], v[100:103], v[40:43]
    s_nop 7
    v_mul_f32 v44, s49, v40
    v_mul_f32 v45, s49, v41
    v_mul_f32 v46, s49, v42
    v_mul_f32 v47, s49, v43
    v_cvt_pk_bf16_f32 v48, v44, v45
    v_cvt_pk_bf16_f32 v49, v46, v47
    s_cmp_ge_u32 s40, 2
    s_cbranch_scc1 K1_STB6
    buffer_store_dwordx2 v[48:49], v107, s[32:35], s48 offen offset:192
    s_branch K1_STD6
K1_STB6:
    buffer_store_dwordx2 v[48:49], v107, s[36:39], s48 offen offset:192
K1_STD6:
    s_nop 1
    ds_read_b64_tr_b16 v[8:9], v105 offset:224
    ds_read_b64_tr_b16 v[10:11], v105 offset:1312
    ds_read_b64_tr_b16 v[12:13], v105 offset:8928
    ds_read_b64_tr_b16 v[14:15], v105 offset:10016
    ds_read_b64_tr_b16 v[16:17], v105 offset:17632
    ds_read_b64_tr_b16 v[18:19], v105 offset:18720
    ds_read_b64_tr_b16 v[20:21], v105 offset:26336
    ds_read_b64_tr_b16 v[22:23], v105 offset:27424
    ds_read_b64_tr_b16 v[24:25], v105 offset:35040
    ds_read_b64_tr_b16 v[26:27], v105 offset:36128
    ds_read_b64_tr_b16 v[28:29], v105 offset:43744
    ds_read_b64_tr_b16 v[30:31], v105 offset:44832
    ds_read_b64_tr_b16 v[32:33], v105 offset:52448
    ds_read_b64_tr_b16 v[34:35], v105 offset:53536
    ds_read_b64_tr_b16 v[36:37], v105 offset:61152
    ds_read_b64_tr_b16 v[38:39], v105 offset:62240
    s_waitcnt lgkmcnt(14)
    v_mfma_f32_16x16x32_bf16 v[40:43], v[8:11], v[72:75], 0
    s_waitcnt lgkmcnt(12)
    v_mfma_f32_16x16x32_bf16 v[40:43], v[12:15], v[76:79], v[40:43]
    s_waitcnt lgkmcnt(10)
    v_mfma_f32_16x16x32_bf16 v[40:43], v[16:19], v[80:83], v[40:43]
    s_waitcnt lgkmcnt(8)
    v_mfma_f32_16x16x32_bf16 v[40:43], v[20:23], v[84:87], v[40:43]
    s_waitcnt lgkmcnt(6)
    v_mfma_f32_16x16x32_bf16 v[40:43], v[24:27], v[88:91], v[40:43]
    s_waitcnt lgkmcnt(4)
    v_mfma_f32_16x16x32_bf16 v[40:43], v[28:31], v[92:95], v[40:43]
    s_waitcnt lgkmcnt(2)
    v_mfma_f32_16x16x32_bf16 v[40:43], v[32:35], v[96:99], v[40:43]
    s_waitcnt lgkmcnt(0)
    v_mfma_f32_16x16x32_bf16 v[40:43], v[36:39], v[100:103], v[40:43]
    s_nop 7
    v_mul_f32 v44, s49, v40
    v_mul_f32 v45, s49, v41
    v_mul_f32 v46, s49, v42
    v_mul_f32 v47, s49, v43
    v_cvt_pk_bf16_f32 v48, v44, v45
    v_cvt_pk_bf16_f32 v49, v46, v47
    s_cmp_ge_u32 s40, 2
    s_cbranch_scc1 K1_STB7
    buffer_store_dwordx2 v[48:49], v107, s[32:35], s48 offen offset:224
    s_branch K1_STD7
K1_STB7:
    buffer_store_dwordx2 v[48:49], v107, s[36:39], s48 offen offset:224
K1_STD7:
    s_nop 1
    s_endpgm
K1_NOTGEMM:
    s_cmp_ge_u32 s2, 785
    s_cbranch_scc1 K1_NOTSORT
    s_sub_u32 s40, s2, 628
    s_waitcnt lgkmcnt(0)
    s_mov_b32 s24, s12
    s_and_b32 s25, s13, 0xffff
    s_mov_b32 s26, 640000
    s_mov_b32 s27, 0x00020000
    s_mov_b32 s28, s10
    s_and_b32 s29, s11, 0xffff
    s_mov_b32 s30, 640000
    s_mov_b32 s31, 0x00020000
    s_mov_b32 s32, s8
    s_and_b32 s33, s9, 0xffff
    s_mov_b32 s34, 320000
    s_mov_b32 s35, 0x00020000
    s_mov_b32 s36, s6
    s_and_b32 s37, s7, 0xffff
    s_mov_b32 s38, 60000
    s_mov_b32 s39, 0x00020000
    v_lshlrev_b32 v1, 2, v0
    v_mov_b32 v2, 0
    ds_write_b32 v1, v2
    ds_write_b32 v1, v2 offset:1024
    s_lshl_b32 s41, s40, 10
    v_lshlrev_b32 v3, 2, v0
    v_add_u32 v3, s41, v3
    v_cmp_gt_u32 vcc, 160000, v3
    s_and_saveexec_b64 s[42:43], vcc
    v_lshlrev_b32 v1, 2, v3
    buffer_load_dwordx4 v[4:7], v1, s[24:27], 0 offen
    buffer_load_dwordx4 v[8:11], v1, s[28:31], 0 offen
    v_lshlrev_b32 v1, 1, v3
    buffer_load_dwordx2 v[12:13], v1, s[32:35], 0 offen
    s_waitcnt lgkmcnt(0)
    s_barrier
    s_waitcnt vmcnt(0)
    s_mov_b32 s44, 0x0CCCCCCD
    v_mul_u32_u24 v1, 6, v4
    v_and_b32 v1, -4, v1
    buffer_load_dwordx2 v[16:17], v1, s[36:39], 0 offen
    v_mul_u32_u24 v1, 6, v8
    v_and_b32 v1, -4, v1
    buffer_load_dwordx2 v[18:19], v1, s[36:39], 0 offen
    v_mul_u32_u24 v1, 6, v5
    v_and_b32 v1, -4, v1
    buffer_load_dwordx2 v[20:21], v1, s[36:39], 0 offen
    v_mul_u32_u24 v1, 6, v9
    v_and_b32 v1, -4, v1
    buffer_load_dwordx2 v[22:23], v1, s[36:39], 0 offen
    v_mul_u32_u24 v1, 6, v6
    v_and_b32 v1, -4, v1
    buffer_load_dwordx2 v[24:25], v1, s[36:39], 0 offen
    v_mul_u32_u24 v1, 6, v10
    v_and_b32 v1, -4, v1
    buffer_load_dwordx2 v[26:27], v1, s[36:39], 0 offen
    v_mul_u32_u24 v1, 6, v7
    v_and_b32 v1, -4, v1
    buffer_load_dwordx2 v[28:29], v1, s[36:39], 0 offen
    v_mul_u32_u24 v1, 6, v11
    v_and_b32 v1, -4, v1
    buffer_load_dwordx2 v[30:31], v1, s[36:39], 0 offen
    v_mul_hi_u32 v32, s44, v4
    v_mul_u32_u24 v1, 20, v32
    v_sub_u32 v36, v4, v1
    v_lshlrev_b32 v1, 2, v32
    v_mov_b32 v2, 1
    ds_add_rtn_u32 v40, v1, v2
    v_mul_hi_u32 v33, s44, v5
    v_mul_u32_u24 v1, 20, v33
    v_sub_u32 v37, v5, v1
    v_lshlrev_b32 v1, 2, v33
    v_mov_b32 v2, 1
    ds_add_rtn_u32 v41, v1, v2
    v_mul_hi_u32 v34, s44, v6
    v_mul_u32_u24 v1, 20, v34
    v_sub_u32 v38, v6, v1
    v_lshlrev_b32 v1, 2, v34
    v_mov_b32 v2, 1
    ds_add_rtn_u32 v42, v1, v2
    v_mul_hi_u32 v35, s44, v7
    v_mul_u32_u24 v1, 20, v35
    v_sub_u32 v39, v7, v1
    v_lshlrev_b32 v1, 2, v35
    v_mov_b32 v2, 1
    ds_add_rtn_u32 v43, v1, v2
    s_waitcnt vmcnt(0)
    v_and_b32 v1, 1, v4
    v_lshlrev_b32 v1, 4, v1
    v_lshrrev_b64 v[16:17], v1, v[16:17]
    v_and_b32 v1, 1, v8
    v_lshlrev_b32 v1, 4, v1
    v_lshrrev_b64 v[18:19], v1, v[18:19]
    v_lshlrev_b32 v1, 16, v16
    v_lshlrev_b32 v2, 16, v18
    v_sub_f32 v44, v1, v2
    v_and_b32 v1, 0xffff0000, v16
    v_and_b32 v2, 0xffff0000, v18
    v_sub_f32 v45, v1, v2
    v_lshlrev_b32 v1, 16, v17
    v_lshlrev_b32 v2, 16, v19
    v_sub_f32 v46, v1, v2
    v_cvt_pk_bf16_f32 v50, v44, v45
    v_cvt_pk_bf16_f32 v51, v46, v46
    v_and_b32 v51, 0xffff, v51
    v_lshlrev_b32 v44, 16, v50
    v_and_b32 v45, 0xffff0000, v50
    v_lshlrev_b32 v46, 16, v51
    v_mul_f32 v44, v44, v44
    v_mul_f32 v45, v45, v45
    v_mul_f32 v46, v46, v46
    v_cvt_pk_bf16_f32 v47, v44, v45
    v_cvt_pk_bf16_f32 v48, v46, v46
    v_lshlrev_b32 v44, 16, v47
    v_and_b32 v45, 0xffff0000, v47
    v_lshlrev_b32 v46, 16, v48
    v_add_f32 v44, v44, v45
    v_add_f32 v44, v44, v46
    v_cvt_pk_bf16_f32 v44, v44, v44
    v_and_b32 v44, 0xffff0000, v44
    v_and_b32 v45, 0xffff, v12
    v_or_b32 v57, v44, v45
    v_lshl_or_b32 v56, v36, 16, v8
    v_mov_b32 v58, v50
    v_mov_b32 v59, v51
    v_and_b32 v1, 1, v5
    v_lshlrev_b32 v1, 4, v1
    v_lshrrev_b64 v[20:21], v1, v[20:21]
    v_and_b32 v1, 1, v9
    v_lshlrev_b32 v1, 4, v1
    v_lshrrev_b64 v[22:23], v1, v[22:23]
    v_lshlrev_b32 v1, 16, v20
    v_lshlrev_b32 v2, 16, v22
    v_sub_f32 v44, v1, v2
    v_and_b32 v1, 0xffff0000, v20
    v_and_b32 v2, 0xffff0000, v22
    v_sub_f32 v45, v1, v2
    v_lshlrev_b32 v1, 16, v21
    v_lshlrev_b32 v2, 16, v23
    v_sub_f32 v46, v1, v2
    v_cvt_pk_bf16_f32 v50, v44, v45
    v_cvt_pk_bf16_f32 v51, v46, v46
    v_and_b32 v51, 0xffff, v51
    v_lshlrev_b32 v44, 16, v50
    v_and_b32 v45, 0xffff0000, v50
    v_lshlrev_b32 v46, 16, v51
    v_mul_f32 v44, v44, v44
    v_mul_f32 v45, v45, v45
    v_mul_f32 v46, v46, v46
    v_cvt_pk_bf16_f32 v47, v44, v45
    v_cvt_pk_bf16_f32 v48, v46, v46
    v_lshlrev_b32 v44, 16, v47
    v_and_b32 v45, 0xffff0000, v47
    v_lshlrev_b32 v46, 16, v48
    v_add_f32 v44, v44, v45
    v_add_f32 v44, v44, v46
    v_cvt_pk_bf16_f32 v44, v44, v44
    v_and_b32 v44, 0xffff0000, v44
    v_lshrrev_b32 v45, 16, v12
    v_or_b32 v61, v44, v45
    v_lshl_or_b32 v60, v37, 16, v9
    v_mov_b32 v62, v50
    v_mov_b32 v63, v51
    v_and_b32 v1, 1, v6
    v_lshlrev_b32 v1, 4, v1
    v_lshrrev_b64 v[24:25], v1, v[24:25]
    v_and_b32 v1, 1, v10
    v_lshlrev_b32 v1, 4, v1
    v_lshrrev_b64 v[26:27], v1, v[26:27]
    v_lshlrev_b32 v1, 16, v24
    v_lshlrev_b32 v2, 16, v26
    v_sub_f32 v44, v1, v2
    v_and_b32 v1, 0xffff0000, v24
    v_and_b32 v2, 0xffff0000, v26
    v_sub_f32 v45, v1, v2
    v_lshlrev_b32 v1, 16, v25
    v_lshlrev_b32 v2, 16, v27
    v_sub_f32 v46, v1, v2
    v_cvt_pk_bf16_f32 v50, v44, v45
    v_cvt_pk_bf16_f32 v51, v46, v46
    v_and_b32 v51, 0xffff, v51
    v_lshlrev_b32 v44, 16, v50
    v_and_b32 v45, 0xffff0000, v50
    v_lshlrev_b32 v46, 16, v51
    v_mul_f32 v44, v44, v44
    v_mul_f32 v45, v45, v45
    v_mul_f32 v46, v46, v46
    v_cvt_pk_bf16_f32 v47, v44, v45
    v_cvt_pk_bf16_f32 v48, v46, v46
    v_lshlrev_b32 v44, 16, v47
    v_and_b32 v45, 0xffff0000, v47
    v_lshlrev_b32 v46, 16, v48
    v_add_f32 v44, v44, v45
    v_add_f32 v44, v44, v46
    v_cvt_pk_bf16_f32 v44, v44, v44
    v_and_b32 v44, 0xffff0000, v44
    v_and_b32 v45, 0xffff, v13
    v_or_b32 v65, v44, v45
    v_lshl_or_b32 v64, v38, 16, v10
    v_mov_b32 v66, v50
    v_mov_b32 v67, v51
    v_and_b32 v1, 1, v7
    v_lshlrev_b32 v1, 4, v1
    v_lshrrev_b64 v[28:29], v1, v[28:29]
    v_and_b32 v1, 1, v11
    v_lshlrev_b32 v1, 4, v1
    v_lshrrev_b64 v[30:31], v1, v[30:31]
    v_lshlrev_b32 v1, 16, v28
    v_lshlrev_b32 v2, 16, v30
    v_sub_f32 v44, v1, v2
    v_and_b32 v1, 0xffff0000, v28
    v_and_b32 v2, 0xffff0000, v30
    v_sub_f32 v45, v1, v2
    v_lshlrev_b32 v1, 16, v29
    v_lshlrev_b32 v2, 16, v31
    v_sub_f32 v46, v1, v2
    v_cvt_pk_bf16_f32 v50, v44, v45
    v_cvt_pk_bf16_f32 v51, v46, v46
    v_and_b32 v51, 0xffff, v51
    v_lshlrev_b32 v44, 16, v50
    v_and_b32 v45, 0xffff0000, v50
    v_lshlrev_b32 v46, 16, v51
    v_mul_f32 v44, v44, v44
    v_mul_f32 v45, v45, v45
    v_mul_f32 v46, v46, v46
    v_cvt_pk_bf16_f32 v47, v44, v45
    v_cvt_pk_bf16_f32 v48, v46, v46
    v_lshlrev_b32 v44, 16, v47
    v_and_b32 v45, 0xffff0000, v47
    v_lshlrev_b32 v46, 16, v48
    v_add_f32 v44, v44, v45
    v_add_f32 v44, v44, v46
    v_cvt_pk_bf16_f32 v44, v44, v44
    v_and_b32 v44, 0xffff0000, v44
    v_lshrrev_b32 v45, 16, v13
    v_or_b32 v69, v44, v45
    v_lshl_or_b32 v68, v39, 16, v11
    v_mov_b32 v70, v50
    v_mov_b32 v71, v51
    s_mov_b64 exec, s[42:43]
    s_waitcnt lgkmcnt(0)
    s_barrier
    v_cmp_gt_u32 vcc, 64, v0
    s_and_saveexec_b64 s[42:43], vcc
    s_cbranch_execz K1_SKIPSCAN
    v_lshlrev_b32 v1, 5, v0
    ds_read_b128 v[80:83], v1
    ds_read_b128 v[84:87], v1 offset:16
    s_waitcnt lgkmcnt(0)
    v_add_u32 v81, v81, v80
    v_add_u32 v82, v82, v81
    v_add_u32 v83, v83, v82
    v_add_u32 v84, v84, v83
    v_add_u32 v85, v85, v84
    v_add_u32 v86, v86, v85
    v_add_u32 v87, v87, v86
    v_mov_b32 v88, v87
    s_nop 1
    v_add_u32_dpp v88, v88, v88 row_shr:1 row_mask:0xf bank_mask:0xf bound_ctrl:0
    s_nop 1
    v_add_u32_dpp v88, v88, v88 row_shr:2 row_mask:0xf bank_mask:0xf bound_ctrl:0
    s_nop 1
    v_add_u32_dpp v88, v88, v88 row_shr:4 row_mask:0xf bank_mask:0xf bound_ctrl:0
    s_nop 1
    v_add_u32_dpp v88, v88, v88 row_shr:8 row_mask:0xf bank_mask:0xf bound_ctrl:0
    s_nop 1
    v_add_u32_dpp v88, v88, v88 row_bcast:15 row_mask:0xa bank_mask:0xf
    s_nop 1
    v_add_u32_dpp v88, v88, v88 row_bcast:31 row_mask:0xc bank_mask:0xf
    v_sub_u32 v88, v88, v87
    v_add_u32 v89, v88, v80
    v_add_u32 v90, v88, v81
    v_add_u32 v91, v88, v82
    v_add_u32 v92, v88, v83
    v_add_u32 v93, v88, v84
    v_add_u32 v94, v88, v85
    v_add_u32 v95, v88, v86
    ds_write_b128 v1, v[88:91]
    ds_write_b128 v1, v[92:95] offset:16
    v_lshl_or_b32 v96, v89, 16, v88
    v_lshl_or_b32 v97, v91, 16, v90
    v_lshl_or_b32 v98, v93, 16, v92
    v_lshl_or_b32 v99, v95, 16, v94
    s_add_u32 s24, s20, 20971520
    s_addc_u32 s25, s21, 0
    s_and_b32 s25, s25, 0xffff
    s_mov_b32 s26, 160768
    s_mov_b32 s27, 0x00020000
    s_lshl_b32 s44, s40, 10
    v_lshlrev_b32 v1, 4, v0
    buffer_store_dwordx4 v[96:99], v1, s[24:27], s44 offen
K1_SKIPSCAN:
    s_mov_b64 exec, s[42:43]
    s_waitcnt lgkmcnt(0)
    s_barrier
    s_add_u32 s28, s20, 22020096
    s_addc_u32 s29, s21, 0
    s_and_b32 s29, s29, 0xffff
    s_mov_b32 s30, 2560000
    s_mov_b32 s31, 0x00020000
    v_cmp_gt_u32 vcc, 160000, v3
    s_and_saveexec_b64 s[42:43], vcc
    v_lshlrev_b32 v1, 2, v32
    ds_read_b32 v44, v1
    v_lshlrev_b32 v1, 2, v33
    ds_read_b32 v45, v1
    v_lshlrev_b32 v1, 2, v34
    ds_read_b32 v46, v1
    v_lshlrev_b32 v1, 2, v35
    ds_read_b32 v47, v1
    s_waitcnt lgkmcnt(0)
    v_add_u32 v1, v44, v40
    v_add_u32 v1, s41, v1
    v_lshlrev_b32 v1, 4, v1
    buffer_store_dwordx4 v[56:59], v1, s[28:31], 0 offen
    v_add_u32 v1, v45, v41
    v_add_u32 v1, s41, v1
    v_lshlrev_b32 v1, 4, v1
    buffer_store_dwordx4 v[60:63], v1, s[28:31], 0 offen
    v_add_u32 v1, v46, v42
    v_add_u32 v1, s41, v1
    v_lshlrev_b32 v1, 4, v1
    buffer_store_dwordx4 v[64:67], v1, s[28:31], 0 offen
    v_add_u32 v1, v47, v43
    v_add_u32 v1, s41, v1
    v_lshlrev_b32 v1, 4, v1
    buffer_store_dwordx4 v[68:71], v1, s[28:31], 0 offen
    s_endpgm
K1_NOTSORT:
    s_cmp_ge_u32 s2, 801
    s_cbranch_scc1 K1_END
    s_sub_u32 s40, s2, 785
    s_waitcnt lgkmcnt(0)
    s_mov_b32 s24, s18
    s_and_b32 s25, s19, 0xffff
    s_mov_b32 s26, 262144
    s_mov_b32 s27, 0x00020000
    s_add_u32 s28, s20, 25165824
    s_addc_u32 s29, s21, 0
    s_and_b32 s29, s29, 0xffff
    s_mov_b32 s30, 262144
    s_mov_b32 s31, 0x00020000
    v_lshlrev_b32 v1, 1, v0
    s_lshl_b32 s41, s40, 14
    s_add_u32 s42, s41, 0
    buffer_load_ushort v32, v1, s[24:27], s42 offen
    s_add_u32 s42, s41, 512
    buffer_load_ushort v33, v1, s[24:27], s42 offen
    s_add_u32 s42, s41, 1024
    buffer_load_ushort v34, v1, s[24:27], s42 offen
    s_add_u32 s42, s41, 1536
    buffer_load_ushort v35, v1, s[24:27], s42 offen
    s_add_u32 s42, s41, 2048
    buffer_load_ushort v36, v1, s[24:27], s42 offen
    s_add_u32 s42, s41, 2560
    buffer_load_ushort v37, v1, s[24:27], s42 offen
    s_add_u32 s42, s41, 3072
    buffer_load_ushort v38, v1, s[24:27], s42 offen
    s_add_u32 s42, s41, 3584
    buffer_load_ushort v39, v1, s[24:27], s42 offen
    s_add_u32 s42, s41, 4096
    buffer_load_ushort v40, v1, s[24:27], s42 offen
    s_add_u32 s42, s41, 4608
    buffer_load_ushort v41, v1, s[24:27], s42 offen
    s_add_u32 s42, s41, 5120
    buffer_load_ushort v42, v1, s[24:27], s42 offen
    s_add_u32 s42, s41, 5632
    buffer_load_ushort v43, v1, s[24:27], s42 offen
    s_add_u32 s42, s41, 6144
    buffer_load_ushort v44, v1, s[24:27], s42 offen
    s_add_u32 s42, s41, 6656
    buffer_load_ushort v45, v1, s[24:27], s42 offen
    s_add_u32 s42, s41, 7168
    buffer_load_ushort v46, v1, s[24:27], s42 offen
    s_add_u32 s42, s41, 7680
    buffer_load_ushort v47, v1, s[24:27], s42 offen
    s_add_u32 s42, s41, 8192
    buffer_load_ushort v48, v1, s[24:27], s42 offen
    s_add_u32 s42, s41, 8704
    buffer_load_ushort v49, v1, s[24:27], s42 offen
    s_add_u32 s42, s41, 9216
    buffer_load_ushort v50, v1, s[24:27], s42 offen
    s_add_u32 s42, s41, 9728
    buffer_load_ushort v51, v1, s[24:27], s42 offen
    s_add_u32 s42, s41, 10240
    buffer_load_ushort v52, v1, s[24:27], s42 offen
    s_add_u32 s42, s41, 10752
    buffer_load_ushort v53, v1, s[24:27], s42 offen
    s_add_u32 s42, s41, 11264
    buffer_load_ushort v54, v1, s[24:27], s42 offen
    s_add_u32 s42, s41, 11776
    buffer_load_ushort v55, v1, s[24:27], s42 offen
    s_add_u32 s42, s41, 12288
    buffer_load_ushort v56, v1, s[24:27], s42 offen
    s_add_u32 s42, s41, 12800
    buffer_load_ushort v57, v1, s[24:27], s42 offen
    s_add_u32 s42, s41, 13312
    buffer_load_ushort v58, v1, s[24:27], s42 offen
    s_add_u32 s42, s41, 13824
    buffer_load_ushort v59, v1, s[24:27], s42 offen
    s_add_u32 s42, s41, 14336
    buffer_load_ushort v60, v1, s[24:27], s42 offen
    s_add_u32 s42, s41, 14848
    buffer_load_ushort v61, v1, s[24:27], s42 offen
    s_add_u32 s42, s41, 15360
    buffer_load_ushort v62, v1, s[24:27], s42 offen
    s_add_u32 s42, s41, 15872
    buffer_load_ushort v63, v1, s[24:27], s42 offen
    s_waitcnt vmcnt(0)
    v_lshl_or_b32 v8, v33, 16, v32
    v_lshl_or_b32 v9, v35, 16, v34
    v_lshl_or_b32 v10, v37, 16, v36
    v_lshl_or_b32 v11, v39, 16, v38
    v_lshl_or_b32 v12, v41, 16, v40
    v_lshl_or_b32 v13, v43, 16, v42
    v_lshl_or_b32 v14, v45, 16, v44
    v_lshl_or_b32 v15, v47, 16, v46
    v_lshl_or_b32 v16, v49, 16, v48
    v_lshl_or_b32 v17, v51, 16, v50
    v_lshl_or_b32 v18, v53, 16, v52
    v_lshl_or_b32 v19, v55, 16, v54
    v_lshl_or_b32 v20, v57, 16, v56
    v_lshl_or_b32 v21, v59, 16, v58
    v_lshl_or_b32 v22, v61, 16, v60
    v_lshl_or_b32 v23, v63, 16, v62
    v_lshlrev_b32 v2, 10, v0
    s_lshl_b32 s41, s40, 6
    s_waitcnt vmcnt(0)
    buffer_store_dwordx4 v[8:11], v2, s[28:31], s41 offen offset:0
    buffer_store_dwordx4 v[12:15], v2, s[28:31], s41 offen offset:16
    buffer_store_dwordx4 v[16:19], v2, s[28:31], s41 offen offset:32
    buffer_store_dwordx4 v[20:23], v2, s[28:31], s41 offen offset:48
K1_END:
    s_endpgm
.globl gather_scatter__cheap_equivariant_egnn__graph_kernel
.p2align 8
.type gather_scatter__cheap_equivariant_egnn__graph_kernel,@function
gather_scatter__cheap_equivariant_egnn__graph_kernel:
    s_cmp_ge_u32 s2, 500
    s_cbranch_scc1 K2_END
    s_load_dwordx16 s[4:19], s[0:1], 0
    s_load_dwordx2 s[20:21], s[0:1], 80
    s_load_dwordx2 s[22:23], s[0:1], 64
    s_setprio 3
    v_and_b32 v1, 63, v0
    v_lshrrev_b32 v2, 6, v0
    s_nop 0
    v_readfirstlane_b32 s60, v2
    s_mul_i32 s61, s2, 20
    s_waitcnt lgkmcnt(0)
    s_add_u32 s24, s20, 20971520
    s_addc_u32 s25, s21, 0
    s_and_b32 s25, s25, 0xffff
    s_mov_b32 s26, 160768
    s_mov_b32 s27, 0x00020000
    s_add_u32 s28, s20, 22020096
    s_addc_u32 s29, s21, 0
    s_and_b32 s29, s29, 0xffff
    s_mov_b32 s30, 2560000
    s_mov_b32 s31, 0x00020000
    s_mov_b32 s32, s20
    s_and_b32 s33, s21, 0xffff
    s_mov_b32 s34, 5120000
    s_mov_b32 s35, 0x00020000
    s_add_u32 s36, s20, 8388608
    s_addc_u32 s37, s21, 0
    s_and_b32 s37, s37, 0xffff
    s_mov_b32 s38, 5120000
    s_mov_b32 s39, 0x00020000
    s_mov_b32 s40, s4
    s_and_b32 s41, s5, 0xffff
    s_mov_b32 s42, 5120000
    s_mov_b32 s43, 0x00020000
    s_mov_b32 s44, s22
    s_and_b32 s45, s23, 0xffff
    s_mov_b32 s46, 5180000
    s_mov_b32 s47, 0x00020000
    s_add_u32 s48, s20, 25165824
    s_addc_u32 s49, s21, 0
    s_and_b32 s49, s49, 0xffff
    s_mov_b32 s50, 262144
    s_mov_b32 s51, 0x00020000
    s_mov_b32 s52, s6
    s_and_b32 s53, s7, 0xffff
    s_mov_b32 s54, 60000
    s_mov_b32 s55, 0x00020000
    s_mov_b32 s56, s14
    s_and_b32 s57, s15, 0xffff
    s_mov_b32 s58, 263168
    s_mov_b32 s59, 0x00020000
    s_mov_b32 s64, s16
    s_and_b32 s65, s17, 0xffff
    s_mov_b32 s66, 512
    s_mov_b32 s67, 0x00020000
    s_and_b32 s62, s60, 3
    s_lshr_b32 s63, s60, 2
    v_cmp_gt_u32 vcc, 157, v0
    s_and_saveexec_b64 s[68:69], vcc
    v_lshlrev_b32 v3, 10, v0
    s_lshl_b32 s70, s2, 1
    buffer_load_ushort v120, v3, s[24:27], s70 offen
    buffer_load_ushort v121, v3, s[24:27], s70 offen offset:2
    s_mov_b64 exec, s[68:69]
    v_lshlrev_b32 v3, 4, v0
    s_lshl_b32 s70, s61, 9
    buffer_load_dwordx4 v[96:99], v3, s[36:39], s70 offen
    v_cmp_gt_u32 vcc, 128, v0
    s_and_saveexec_b64 s[68:69], vcc
    s_add_u32 s71, s70, 8192
    buffer_load_dwordx4 v[100:103], v3, s[36:39], s71 offen
    v_lshrrev_b32 v4, 6, v0
    v_sub_u32 v4, 513, v4
    v_lshlrev_b32 v4, 9, v4
    v_lshl_add_u32 v4, v1, 3, v4
    buffer_load_dwordx2 v[104:105], v4, s[56:59], 0 offen
    s_mov_b64 exec, s[68:69]
    v_and_b32 v5, 15, v1
    v_lshlrev_b32 v5, 3, v5
    s_lshl_b32 s72, s62, 7
    buffer_load_dwordx2 v[106:107], v5, s[64:67], s72 offen
    v_mov_b32 v108, 0
    v_mov_b32 v109, 0
    v_mov_b32 v110, 0
    v_mov_b32 v111, 0
    v_mov_b32 v6, 66560
    ds_write_b32 v6, v108
    v_cmp_gt_u32 vcc, 320, v0
    s_and_saveexec_b64 s[68:69], vcc
    ds_write_b128 v3, v[108:111] offset:15360
    s_mov_b64 exec, s[68:69]
    s_waitcnt vmcnt(0)
    ds_write_b128 v3, v[96:99] offset:4096
    v_cmp_gt_u32 vcc, 128, v0
    s_and_saveexec_b64 s[68:69], vcc
    ds_write_b128 v3, v[100:103] offset:12288
    s_mov_b32 s70, 0xbfb8aa3b
    v_lshlrev_b32 v108, 16, v104
    v_and_b32 v109, 0xffff0000, v104
    v_lshlrev_b32 v110, 16, v105
    v_and_b32 v111, 0xffff0000, v105
    v_mul_f32 v108, s70, v108
    v_mul_f32 v109, s70, v109
    v_mul_f32 v110, s70, v110
    v_mul_f32 v111, s70, v111
    v_cvt_pk_bf16_f32 v108, v108, v109
    v_cvt_pk_bf16_f32 v109, v110, v111
    v_lshlrev_b32 v4, 3, v0
    ds_write_b64 v4, v[108:109] offset:14336
    s_mov_b64 exec, s[68:69]
    s_mov_b32 s70, 0xbf317218
    v_lshlrev_b32 v10, 16, v106
    v_and_b32 v11, 0xffff0000, v106
    v_lshlrev_b32 v12, 16, v107
    v_and_b32 v13, 0xffff0000, v107
    v_mul_f32 v10, s70, v10
    v_mul_f32 v11, s70, v11
    v_mul_f32 v12, s70, v12
    v_mul_f32 v13, s70, v13
    s_waitcnt lgkmcnt(0)
    s_barrier
    v_cmp_gt_u32 vcc, 157, v0
    s_and_saveexec_b64 s[68:69], vcc
    v_sub_u32 v122, v121, v120
    v_mov_b32 v3, 66560
    ds_add_rtn_u32 v123, v3, v122
    v_lshl_add_u32 v120, v0, 10, v120
    v_lshlrev_b32 v120, 4, v120
    v_mov_b32 v121, v122
    v_lshlrev_b32 v3, 4, v0
    v_add_u32 v3, 66576, v3
    s_waitcnt lgkmcnt(0)
    v_mov_b32 v122, v123
    ds_write_b96 v3, v[120:122]
    s_mov_b64 exec, s[68:69]
    v_lshrrev_b32 v2, 4, v1
    v_lshlrev_b32 v3, 12, v2
    v_add_u32 v3, v3, v5
    v_add_u32 v3, s72, v3
    ds_read_b64 v[96:97], v3 offset:4096
    ds_read_b64 v[98:99], v3 offset:4608
    ds_read_b64 v[100:101], v3 offset:5120
    ds_read_b64 v[102:103], v3 offset:5632
    ds_read_b64 v[104:105], v3 offset:6144
    ds_read_b64 v[106:107], v3 offset:6656
    ds_read_b64 v[108:109], v3 offset:7168
    ds_read_b64 v[110:111], v3 offset:7680
    s_mov_b32 s70, 0x05040100
    s_mov_b32 s71, 0x07060302
    s_waitcnt lgkmcnt(0)
    v_perm_b32 v16, v98, v96, s70
    v_perm_b32 v17, v102, v100, s70
    v_perm_b32 v18, v106, v104, s70
    v_perm_b32 v19, v110, v108, s70
    v_perm_b32 v20, v98, v96, s71
    v_perm_b32 v21, v102, v100, s71
    v_perm_b32 v22, v106, v104, s71
    v_perm_b32 v23, v110, v108, s71
    v_perm_b32 v24, v99, v97, s70
    v_perm_b32 v25, v103, v101, s70
    v_perm_b32 v26, v107, v105, s70
    v_perm_b32 v27, v111, v109, s70
    v_perm_b32 v28, v99, v97, s71
    v_perm_b32 v29, v103, v101, s71
    v_perm_b32 v30, v107, v105, s71
    v_perm_b32 v31, v111, v109, s71
    v_mov_b32 v32, 0
    v_mov_b32 v33, 0
    v_mov_b32 v34, 0
    v_mov_b32 v35, 0
    v_mov_b32 v36, 0
    v_mov_b32 v37, 0
    v_mov_b32 v38, 0
    v_mov_b32 v39, 0
    v_mov_b32 v40, 0
    v_mov_b32 v41, 0
    v_mov_b32 v42, 0
    v_mov_b32 v43, 0
    v_mov_b32 v44, 0
    v_mov_b32 v45, 0
    v_mov_b32 v46, 0
    v_mov_b32 v47, 0
    v_mov_b32 v48, 0
    v_mov_b32 v49, 0
    v_mov_b32 v50, 0
    v_mov_b32 v51, 0
    v_mov_b32 v52, 0
    v_mov_b32 v53, 0
    v_mov_b32 v54, 0
    v_mov_b32 v55, 0
    v_mov_b32 v56, 0
    v_mov_b32 v57, 0
    v_mov_b32 v58, 0
    v_mov_b32 v59, 0
    v_mov_b32 v60, 0
    v_mov_b32 v61, 0
    v_mov_b32 v62, 0
    v_mov_b32 v63, 0
    v_mov_b32 v64, 0
    v_mov_b32 v65, 0
    v_mov_b32 v66, 0
    v_mov_b32 v67, 0
    v_mov_b32 v68, 0
    v_mov_b32 v69, 0
    v_mov_b32 v70, 0
    v_mov_b32 v71, 0
    v_mov_b32 v72, 0
    v_mov_b32 v73, 0
    v_mov_b32 v74, 0
    v_mov_b32 v75, 0
    v_mov_b32 v76, 0
    v_mov_b32 v77, 0
    v_mov_b32 v78, 0
    v_mov_b32 v79, 0
    v_mov_b32 v1, v5
    s_barrier
    v_mov_b32 v3, 66560
    ds_read_b32 v4, v3
    s_waitcnt lgkmcnt(0)
    v_readfirstlane_b32 s66, v4
    s_mov_b32 s67, 0
    s_cmp_ge_u32 s60, 3
    s_cbranch_scc1 K2_GDONEA
    v_cmp_gt_u32 vcc, 157, v0
    s_and_saveexec_b64 s[68:69], vcc
    v_lshlrev_b32 v3, 4, v0
    v_add_u32 v3, 66576, v3
    ds_read_b96 v[120:122], v3
    s_waitcnt lgkmcnt(0)
    v_mov_b32 v123, v122
    v_mov_b32 v122, v121
    v_max_u32 v96, s67, v123
    v_add_u32 v97, v123, v122
    s_add_u32 s70, s67, 256
    v_min_u32 v97, s70, v97
    v_sub_u32 v98, v96, v123
    v_lshl_add_u32 v98, v98, 4, v120
    v_subrev_u32 v96, s67, v96
    v_subrev_u32 v97, s67, v97
    s_mov_b32 s74, 0x3f80
K2_GLOOPA:
    v_cmp_lt_i32 vcc, v96, v97
    s_and_b64 exec, exec, vcc
    s_cbranch_execz K2_GENDA
    s_mov_b64 s[76:77], exec
    v_add_u32 v99, 0, v96
    v_cmp_lt_i32 vcc, v99, v97
    s_and_b64 exec, exec, vcc
    buffer_load_dwordx4 v[80:83], v98, s[28:31], 0 offen offset:0
    v_add_u32 v99, 1, v96
    v_cmp_lt_i32 vcc, v99, v97
    s_and_b64 exec, exec, vcc
    buffer_load_dwordx4 v[84:87], v98, s[28:31], 0 offen offset:16
    v_add_u32 v99, 2, v96
    v_cmp_lt_i32 vcc, v99, v97
    s_and_b64 exec, exec, vcc
    buffer_load_dwordx4 v[88:91], v98, s[28:31], 0 offen offset:32
    v_add_u32 v99, 3, v96
    v_cmp_lt_i32 vcc, v99, v97
    s_and_b64 exec, exec, vcc
    buffer_load_dwordx4 v[92:95], v98, s[28:31], 0 offen offset:48
    s_mov_b64 exec, s[76:77]
    s_waitcnt vmcnt(0)
    v_cmp_lt_i32 vcc, v96, v97
    s_and_b64 exec, exec, vcc
    v_lshlrev_b32 v99, 4, v96
    v_add_u32 v99, 69632, v99
    ds_write_b128 v99, v[80:83]
    v_add_u32 v96, 1, v96
    v_cmp_lt_i32 vcc, v96, v97
    s_and_b64 exec, exec, vcc
    v_lshlrev_b32 v99, 4, v96
    v_add_u32 v99, 69632, v99
    ds_write_b128 v99, v[84:87]
    v_add_u32 v96, 1, v96
    v_cmp_lt_i32 vcc, v96, v97
    s_and_b64 exec, exec, vcc
    v_lshlrev_b32 v99, 4, v96
    v_add_u32 v99, 69632, v99
    ds_write_b128 v99, v[88:91]
    v_add_u32 v96, 1, v96
    v_cmp_lt_i32 vcc, v96, v97
    s_and_b64 exec, exec, vcc
    v_lshlrev_b32 v99, 4, v96
    v_add_u32 v99, 69632, v99
    ds_write_b128 v99, v[92:95]
    v_add_u32 v96, 1, v96
    s_mov_b64 exec, s[76:77]
    v_add_u32 v98, 64, v98
    s_branch K2_GLOOPA
K2_GENDA:
    s_mov_b64 exec, s[68:69]
K2_GDONEA:
K2_ROUND:
    v_mov_b32 v96, 0
    v_mov_b32 v97, 0
    v_mov_b32 v98, 0
    v_mov_b32 v99, 0
    v_lshlrev_b32 v3, 4, v0
    ds_write_b128 v3, v[96:99] offset:0
    ds_write_b128 v3, v[96:99] offset:8192
    ds_write_b128 v3, v[96:99] offset:16384
    ds_write_b128 v3, v[96:99] offset:24576
    ds_write_b128 v3, v[96:99] offset:32768
    ds_write_b128 v3, v[96:99] offset:40960
    ds_write_b128 v3, v[96:99] offset:49152
    ds_write_b128 v3, v[96:99] offset:57344
    v_cmp_gt_u32 vcc, 64, v0
    s_and_saveexec_b64 s[68:69], vcc
    v_add_u32 v4, 32768, v3
    ds_write_b128 v4, v[96:99] offset:32768
    s_mov_b64 exec, s[68:69]
    s_waitcnt lgkmcnt(0)
    s_barrier
    s_sub_u32 s70, s66, s67
    s_min_u32 s70, s70, 256
    s_mov_b32 s74, 0x3f80
    v_cmp_gt_u32 vcc, s70, v0
    s_and_saveexec_b64 s[68:69], vcc
    v_mov_b32 v96, v0
    v_lshlrev_b32 v99, 4, v96
    v_add_u32 v99, 69632, v99
    ds_read_b128 v[80:83], v99
    s_waitcnt lgkmcnt(0)
    v_lshrrev_b32 v104, 5, v96
    v_mul_u32_u24 v104, 8320, v104
    v_and_b32 v105, 31, v96
    v_bfe_u32 v106, v96, 2, 2
    v_bfe_u32 v107, v96, 4, 1
    v_lshlrev_b32 v107, 3, v107
    v_and_b32 v108, 3, v96
    v_lshl_add_u32 v107, v108, 1, v107
    v_add_u32 v107, v107, v104
    v_lshl_add_u32 v108, v105, 6, v104
    v_lshl_add_u32 v109, v105, 2, v104
    v_xor_b32 v110, 2, v106
    v_lshl_add_u32 v110, v110, 4, v108
    ds_write_b32 v110, v81 offset:8
    v_lshrrev_b32 v111, 16, v80
    v_and_b32 v112, 0xffff, v80
    v_lshlrev_b32 v112, 9, v112
    ds_write_b32 v109, v112 offset:8192
    v_lshrrev_b32 v112, 3, v111
    v_xor_b32 v112, v112, v106
    v_lshl_add_u32 v112, v112, 4, v108
    v_and_b32 v113, 7, v111
    v_lshl_add_u32 v112, v113, 1, v112
    v_mov_b32 v114, s74
    ds_write_b16 v112, v114
    v_mov_b32 v112, v111
    v_bfe_u32 v113, v112, 2, 2
    v_xor_b32 v113, v113, v106
    v_lshlrev_b32 v113, 4, v113
    v_lshl_add_u32 v113, v112, 6, v113
    v_add_u32 v113, v113, v107
    ds_write_b16 v113, v114 offset:2048
    v_add_u32 v112, 0, v111
    v_bfe_u32 v113, v112, 2, 2
    v_xor_b32 v113, v113, v106
    v_lshlrev_b32 v113, 4, v113
    v_lshl_add_u32 v113, v112, 6, v113
    v_add_u32 v113, v113, v107
    ds_write_b16 v113, v82 offset:4096
    v_add_u32 v112, 20, v111
    v_bfe_u32 v113, v112, 2, 2
    v_xor_b32 v113, v113, v106
    v_lshlrev_b32 v113, 4, v113
    v_lshl_add_u32 v113, v112, 6, v113
    v_add_u32 v113, v113, v107
    ds_write_b16_d16_hi v113, v82 offset:4096
    v_add_u32 v112, 40, v111
    v_bfe_u32 v113, v112, 2, 2
    v_xor_b32 v113, v113, v106
    v_lshlrev_b32 v113, 4, v113
    v_lshl_add_u32 v113, v112, 6, v113
    v_add_u32 v113, v113, v107
    ds_write_b16 v113, v83 offset:4096
    s_mov_b64 exec, s[68:69]
    s_waitcnt lgkmcnt(0)
    s_barrier
    s_setprio 0
    s_sub_u32 s70, s66, s67
    s_min_u32 s70, s70, 256
    s_add_u32 s70, s70, 31
    s_lshr_b32 s71, s70, 5
    s_mov_b32 s70, s63
    s_cmp_ge_u32 s70, s71
    s_cbranch_scc1 K2_CDONE
    v_and_b32 v4, 15, v0
    v_bfe_u32 v2, v0, 4, 2
    v_bfe_u32 v6, v0, 2, 2
    v_xor_b32 v6, v6, v2
    v_lshlrev_b32 v6, 4, v6
    v_lshl_add_u32 v6, v4, 6, v6
    s_mul_i32 s73, s63, 8320
    v_add_u32 v14, s73, v6
    v_lshlrev_b32 v7, 4, v2
    s_add_u32 s73, s73, 8192
    v_add_u32 v15, s73, v7
    ds_read_b128 v[88:91], v15
    ds_read_b128 v[92:95], v15 offset:64
    s_waitcnt lgkmcnt(0)
    v_add_u32 v88, v88, v1
    v_add_u32 v89, v89, v1
    v_add_u32 v90, v90, v1
    v_add_u32 v91, v91, v1
    v_add_u32 v92, v92, v1
    v_add_u32 v93, v93, v1
    v_add_u32 v94, v94, v1
    v_add_u32 v95, v95, v1
    buffer_load_dwordx2 v[80:81], v88, s[32:35], s72 offen
    buffer_load_dwordx2 v[82:83], v89, s[32:35], s72 offen
    buffer_load_dwordx2 v[84:85], v90, s[32:35], s72 offen
    buffer_load_dwordx2 v[86:87], v91, s[32:35], s72 offen
    buffer_load_dwordx2 v[88:89], v92, s[32:35], s72 offen
    buffer_load_dwordx2 v[90:91], v93, s[32:35], s72 offen
    buffer_load_dwordx2 v[92:93], v94, s[32:35], s72 offen
    buffer_load_dwordx2 v[94:95], v95, s[32:35], s72 offen
    v_add_u32 v15, 16640, v15
K2_BLK:
    ds_read_b128 v[2:5], v14
    ds_read_b128 v[6:9], v14 offset:1024
    s_waitcnt vmcnt(0)
    v_lshlrev_b32 v96, 16, v80
    v_and_b32 v100, 0xffff0000, v80
    v_lshlrev_b32 v104, 16, v81
    v_and_b32 v108, 0xffff0000, v81
    v_lshlrev_b32 v97, 16, v82
    v_and_b32 v101, 0xffff0000, v82
    v_lshlrev_b32 v105, 16, v83
    v_and_b32 v109, 0xffff0000, v83
    v_lshlrev_b32 v98, 16, v84
    v_and_b32 v102, 0xffff0000, v84
    v_lshlrev_b32 v106, 16, v85
    v_and_b32 v110, 0xffff0000, v85
    v_lshlrev_b32 v99, 16, v86
    v_and_b32 v103, 0xffff0000, v86
    v_lshlrev_b32 v107, 16, v87
    v_and_b32 v111, 0xffff0000, v87
    v_lshlrev_b32 v112, 16, v88
    v_and_b32 v116, 0xffff0000, v88
    v_lshlrev_b32 v120, 16, v89
    v_and_b32 v124, 0xffff0000, v89
    v_lshlrev_b32 v113, 16, v90
    v_and_b32 v117, 0xffff0000, v90
    v_lshlrev_b32 v121, 16, v91
    v_and_b32 v125, 0xffff0000, v91
    v_lshlrev_b32 v114, 16, v92
    v_and_b32 v118, 0xffff0000, v92
    v_lshlrev_b32 v122, 16, v93
    v_and_b32 v126, 0xffff0000, v93
    v_lshlrev_b32 v115, 16, v94
    v_and_b32 v119, 0xffff0000, v94
    v_lshlrev_b32 v123, 16, v95
    v_and_b32 v127, 0xffff0000, v95
    s_add_u32 s70, s70, 2
    s_cmp_ge_u32 s70, s71
    s_cbranch_scc1 K2_NOPF
    ds_read_b128 v[88:91], v15
    ds_read_b128 v[92:95], v15 offset:64
    s_waitcnt lgkmcnt(0)
    v_add_u32 v88, v88, v1
    v_add_u32 v89, v89, v1
    v_add_u32 v90, v90, v1
    v_add_u32 v91, v91, v1
    v_add_u32 v92, v92, v1
    v_add_u32 v93, v93, v1
    v_add_u32 v94, v94, v1
    v_add_u32 v95, v95, v1
    buffer_load_dwordx2 v[80:81], v88, s[32:35], s72 offen
    buffer_load_dwordx2 v[82:83], v89, s[32:35], s72 offen
    buffer_load_dwordx2 v[84:85], v90, s[32:35], s72 offen
    buffer_load_dwordx2 v[86:87], v91, s[32:35], s72 offen
    buffer_load_dwordx2 v[88:89], v92, s[32:35], s72 offen
    buffer_load_dwordx2 v[90:91], v93, s[32:35], s72 offen
    buffer_load_dwordx2 v[92:93], v94, s[32:35], s72 offen
    buffer_load_dwordx2 v[94:95], v95, s[32:35], s72 offen
    v_add_u32 v15, 16640, v15
K2_NOPF:
    s_waitcnt lgkmcnt(0)
    v_mfma_f32_16x16x32_bf16 v[96:99], v[2:5], v[16:19], v[96:99]
    v_mfma_f32_16x16x32_bf16 v[100:103], v[2:5], v[20:23], v[100:103]
    v_mfma_f32_16x16x32_bf16 v[104:107], v[2:5], v[24:27], v[104:107]
    v_mfma_f32_16x16x32_bf16 v[108:111], v[2:5], v[28:31], v[108:111]
    v_mfma_f32_16x16x32_bf16 v[112:115], v[6:9], v[16:19], v[112:115]
    v_mfma_f32_16x16x32_bf16 v[116:119], v[6:9], v[20:23], v[116:119]
    v_mfma_f32_16x16x32_bf16 v[120:123], v[6:9], v[24:27], v[120:123]
    v_mfma_f32_16x16x32_bf16 v[124:127], v[6:9], v[28:31], v[124:127]
    s_nop 0
    v_exp_f32 v2, v96
    v_exp_f32 v3, v97
    v_exp_f32 v4, v98
    v_exp_f32 v5, v99
    v_exp_f32 v6, v100
    v_exp_f32 v7, v101
    v_exp_f32 v8, v102
    v_exp_f32 v9, v103
    v_pk_add_f32 v[2:3], v[2:3], 1.0 op_sel_hi:[1,0]
    v_pk_add_f32 v[4:5], v[4:5], 1.0 op_sel_hi:[1,0]
    v_pk_add_f32 v[6:7], v[6:7], 1.0 op_sel_hi:[1,0]
    v_pk_add_f32 v[8:9], v[8:9], 1.0 op_sel_hi:[1,0]
    v_rcp_f32 v2, v2
    v_rcp_f32 v3, v3
    v_rcp_f32 v4, v4
    v_rcp_f32 v5, v5
    v_rcp_f32 v6, v6
    v_rcp_f32 v7, v7
    v_rcp_f32 v8, v8
    v_rcp_f32 v9, v9
    v_pk_mul_f32 v[96:97], v[96:97], v[2:3]
    v_pk_mul_f32 v[98:99], v[98:99], v[4:5]
    v_pk_mul_f32 v[100:101], v[100:101], v[6:7]
    v_pk_mul_f32 v[102:103], v[102:103], v[8:9]
    v_exp_f32 v2, v104
    v_exp_f32 v3, v105
    v_exp_f32 v4, v106
    v_exp_f32 v5, v107
    v_exp_f32 v6, v108
    v_exp_f32 v7, v109
    v_exp_f32 v8, v110
    v_exp_f32 v9, v111
    v_pk_add_f32 v[2:3], v[2:3], 1.0 op_sel_hi:[1,0]
    v_pk_add_f32 v[4:5], v[4:5], 1.0 op_sel_hi:[1,0]
    v_pk_add_f32 v[6:7], v[6:7], 1.0 op_sel_hi:[1,0]
    v_pk_add_f32 v[8:9], v[8:9], 1.0 op_sel_hi:[1,0]
    v_rcp_f32 v2, v2
    v_rcp_f32 v3, v3
    v_rcp_f32 v4, v4
    v_rcp_f32 v5, v5
    v_rcp_f32 v6, v6
    v_rcp_f32 v7, v7
    v_rcp_f32 v8, v8
    v_rcp_f32 v9, v9
    v_pk_mul_f32 v[104:105], v[104:105], v[2:3]
    v_pk_mul_f32 v[106:107], v[106:107], v[4:5]
    v_pk_mul_f32 v[108:109], v[108:109], v[6:7]
    v_pk_mul_f32 v[110:111], v[110:111], v[8:9]
    v_exp_f32 v2, v112
    v_exp_f32 v3, v113
    v_exp_f32 v4, v114
    v_exp_f32 v5, v115
    v_exp_f32 v6, v116
    v_exp_f32 v7, v117
    v_exp_f32 v8, v118
    v_exp_f32 v9, v119
    v_pk_add_f32 v[2:3], v[2:3], 1.0 op_sel_hi:[1,0]
    v_pk_add_f32 v[4:5], v[4:5], 1.0 op_sel_hi:[1,0]
    v_pk_add_f32 v[6:7], v[6:7], 1.0 op_sel_hi:[1,0]
    v_pk_add_f32 v[8:9], v[8:9], 1.0 op_sel_hi:[1,0]
    v_rcp_f32 v2, v2
    v_rcp_f32 v3, v3
    v_rcp_f32 v4, v4
    v_rcp_f32 v5, v5
    v_rcp_f32 v6, v6
    v_rcp_f32 v7, v7
    v_rcp_f32 v8, v8
    v_rcp_f32 v9, v9
    v_pk_mul_f32 v[112:113], v[112:113], v[2:3]
    v_pk_mul_f32 v[114:115], v[114:115], v[4:5]
    v_pk_mul_f32 v[116:117], v[116:117], v[6:7]
    v_pk_mul_f32 v[118:119], v[118:119], v[8:9]
    v_exp_f32 v2, v120
    v_exp_f32 v3, v121
    v_exp_f32 v4, v122
    v_exp_f32 v5, v123
    v_exp_f32 v6, v124
    v_exp_f32 v7, v125
    v_exp_f32 v8, v126
    v_exp_f32 v9, v127
    v_pk_add_f32 v[2:3], v[2:3], 1.0 op_sel_hi:[1,0]
    v_pk_add_f32 v[4:5], v[4:5], 1.0 op_sel_hi:[1,0]
    v_pk_add_f32 v[6:7], v[6:7], 1.0 op_sel_hi:[1,0]
    v_pk_add_f32 v[8:9], v[8:9], 1.0 op_sel_hi:[1,0]
    v_rcp_f32 v2, v2
    v_rcp_f32 v3, v3
    v_rcp_f32 v4, v4
    v_rcp_f32 v5, v5
    v_rcp_f32 v6, v6
    v_rcp_f32 v7, v7
    v_rcp_f32 v8, v8
    v_rcp_f32 v9, v9
    v_pk_mul_f32 v[120:121], v[120:121], v[2:3]
    v_pk_mul_f32 v[122:123], v[122:123], v[4:5]
    v_pk_mul_f32 v[124:125], v[124:125], v[6:7]
    v_pk_mul_f32 v[126:127], v[126:127], v[8:9]
    v_pk_mul_f32 v[2:3], v[96:97], v[10:11] op_sel:[0,0] op_sel_hi:[1,0]
    v_pk_fma_f32 v[2:3], v[100:101], v[10:11], v[2:3] op_sel:[0,1,0] op_sel_hi:[1,1,1]
    v_pk_fma_f32 v[2:3], v[104:105], v[12:13], v[2:3] op_sel:[0,0,0] op_sel_hi:[1,0,1]
    v_pk_fma_f32 v[2:3], v[108:109], v[12:13], v[2:3] op_sel:[0,1,0] op_sel_hi:[1,1,1]
    v_pk_mul_f32 v[4:5], v[98:99], v[10:11] op_sel:[0,0] op_sel_hi:[1,0]
    v_pk_fma_f32 v[4:5], v[102:103], v[10:11], v[4:5] op_sel:[0,1,0] op_sel_hi:[1,1,1]
    v_pk_fma_f32 v[4:5], v[106:107], v[12:13], v[4:5] op_sel:[0,0,0] op_sel_hi:[1,0,1]
    v_pk_fma_f32 v[4:5], v[110:111], v[12:13], v[4:5] op_sel:[0,1,0] op_sel_hi:[1,1,1]
    v_pk_mul_f32 v[6:7], v[112:113], v[10:11] op_sel:[0,0] op_sel_hi:[1,0]
    v_pk_fma_f32 v[6:7], v[116:117], v[10:11], v[6:7] op_sel:[0,1,0] op_sel_hi:[1,1,1]
    v_pk_fma_f32 v[6:7], v[120:121], v[12:13], v[6:7] op_sel:[0,0,0] op_sel_hi:[1,0,1]
    v_pk_fma_f32 v[6:7], v[124:125], v[12:13], v[6:7] op_sel:[0,1,0] op_sel_hi:[1,1,1]
    v_pk_mul_f32 v[8:9], v[114:115], v[10:11] op_sel:[0,0] op_sel_hi:[1,0]
    v_pk_fma_f32 v[8:9], v[118:119], v[10:11], v[8:9] op_sel:[0,1,0] op_sel_hi:[1,1,1]
    v_pk_fma_f32 v[8:9], v[122:123], v[12:13], v[8:9] op_sel:[0,0,0] op_sel_hi:[1,0,1]
    v_pk_fma_f32 v[8:9], v[126:127], v[12:13], v[8:9] op_sel:[0,1,0] op_sel_hi:[1,1,1]
    v_cvt_pk_bf16_f32 v96, v96, v97
    v_cvt_pk_bf16_f32 v97, v98, v99
    v_cvt_pk_bf16_f32 v98, v112, v113
    v_cvt_pk_bf16_f32 v99, v114, v115
    v_cvt_pk_bf16_f32 v100, v100, v101
    v_cvt_pk_bf16_f32 v101, v102, v103
    v_cvt_pk_bf16_f32 v102, v116, v117
    v_cvt_pk_bf16_f32 v103, v118, v119
    v_cvt_pk_bf16_f32 v104, v104, v105
    v_cvt_pk_bf16_f32 v105, v106, v107
    v_cvt_pk_bf16_f32 v106, v120, v121
    v_cvt_pk_bf16_f32 v107, v122, v123
    v_cvt_pk_bf16_f32 v108, v108, v109
    v_cvt_pk_bf16_f32 v109, v110, v111
    v_cvt_pk_bf16_f32 v110, v124, v125
    v_cvt_pk_bf16_f32 v111, v126, v127
    v_cvt_pk_bf16_f32 v112, v2, v3
    v_cvt_pk_bf16_f32 v113, v4, v5
    v_cvt_pk_bf16_f32 v114, v6, v7
    v_cvt_pk_bf16_f32 v115, v8, v9
    ds_read_b128 v[116:119], v14 offset:2048
    ds_read_b128 v[124:127], v14 offset:3072
    ds_read_b128 v[2:5], v14 offset:4096
    ds_read_b128 v[6:9], v14 offset:5120
    s_waitcnt lgkmcnt(3)
    v_mfma_f32_16x16x32_bf16 v[32:35], v[116:119], v[96:99], v[32:35]
    v_mfma_f32_16x16x32_bf16 v[36:39], v[116:119], v[100:103], v[36:39]
    v_mfma_f32_16x16x32_bf16 v[40:43], v[116:119], v[104:107], v[40:43]
    v_mfma_f32_16x16x32_bf16 v[44:47], v[116:119], v[108:111], v[44:47]
    s_waitcnt lgkmcnt(2)
    v_mfma_f32_16x16x32_bf16 v[48:51], v[124:127], v[96:99], v[48:51]
    v_mfma_f32_16x16x32_bf16 v[52:55], v[124:127], v[100:103], v[52:55]
    v_mfma_f32_16x16x32_bf16 v[56:59], v[124:127], v[104:107], v[56:59]
    v_mfma_f32_16x16x32_bf16 v[60:63], v[124:127], v[108:111], v[60:63]
    ds_read_b128 v[116:119], v14 offset:6144
    ds_read_b128 v[124:127], v14 offset:7168
    s_waitcnt lgkmcnt(3)
    v_mfma_f32_16x16x32_bf16 v[64:67], v[2:5], v[112:115], v[64:67]
    s_waitcnt lgkmcnt(2)
    v_mfma_f32_16x16x32_bf16 v[68:71], v[6:9], v[112:115], v[68:71]
    s_waitcnt lgkmcnt(1)
    v_mfma_f32_16x16x32_bf16 v[72:75], v[116:119], v[112:115], v[72:75]
    s_waitcnt lgkmcnt(0)
    v_mfma_f32_16x16x32_bf16 v[76:79], v[124:127], v[112:115], v[76:79]
    v_add_u32 v14, 16640, v14
    s_cmp_lt_u32 s70, s71
    s_cbranch_scc1 K2_BLK
K2_CDONE:
    s_waitcnt vmcnt(0) lgkmcnt(0)
    s_setprio 3
    s_add_u32 s78, s67, 256
    s_cmp_ge_u32 s78, s66
    s_cbranch_scc1 K2_NOS1
    s_cmp_ge_u32 s60, 3
    s_cbranch_scc1 K2_GDONEB
    v_cmp_gt_u32 vcc, 157, v0
    s_and_saveexec_b64 s[68:69], vcc
    v_lshlrev_b32 v3, 4, v0
    v_add_u32 v3, 66576, v3
    ds_read_b96 v[120:122], v3
    s_waitcnt lgkmcnt(0)
    v_mov_b32 v123, v122
    v_mov_b32 v122, v121
    v_max_u32 v96, s78, v123
    v_add_u32 v97, v123, v122
    s_add_u32 s70, s78, 256
    v_min_u32 v97, s70, v97
    v_sub_u32 v98, v96, v123
    v_lshl_add_u32 v98, v98, 4, v120
    v_subrev_u32 v96, s78, v96
    v_subrev_u32 v97, s78, v97
    s_mov_b32 s74, 0x3f80
K2_GLOOPB:
    v_cmp_lt_i32 vcc, v96, v97
    s_and_b64 exec, exec, vcc
    s_cbranch_execz K2_GENDB
    s_mov_b64 s[76:77], exec
    v_add_u32 v99, 0, v96
    v_cmp_lt_i32 vcc, v99, v97
    s_and_b64 exec, exec, vcc
    buffer_load_dwordx4 v[80:83], v98, s[28:31], 0 offen offset:0
    v_add_u32 v99, 1, v96
    v_cmp_lt_i32 vcc, v99, v97
    s_and_b64 exec, exec, vcc
    buffer_load_dwordx4 v[84:87], v98, s[28:31], 0 offen offset:16
    v_add_u32 v99, 2, v96
    v_cmp_lt_i32 vcc, v99, v97
    s_and_b64 exec, exec, vcc
    buffer_load_dwordx4 v[88:91], v98, s[28:31], 0 offen offset:32
    v_add_u32 v99, 3, v96
    v_cmp_lt_i32 vcc, v99, v97
    s_and_b64 exec, exec, vcc
    buffer_load_dwordx4 v[92:95], v98, s[28:31], 0 offen offset:48
    s_mov_b64 exec, s[76:77]
    s_waitcnt vmcnt(0)
    v_cmp_lt_i32 vcc, v96, v97
    s_and_b64 exec, exec, vcc
    v_lshlrev_b32 v99, 4, v96
    v_add_u32 v99, 69632, v99
    ds_write_b128 v99, v[80:83]
    v_add_u32 v96, 1, v96
    v_cmp_lt_i32 vcc, v96, v97
    s_and_b64 exec, exec, vcc
    v_lshlrev_b32 v99, 4, v96
    v_add_u32 v99, 69632, v99
    ds_write_b128 v99, v[84:87]
    v_add_u32 v96, 1, v96
    v_cmp_lt_i32 vcc, v96, v97
    s_and_b64 exec, exec, vcc
    v_lshlrev_b32 v99, 4, v96
    v_add_u32 v99, 69632, v99
    ds_write_b128 v99, v[88:91]
    v_add_u32 v96, 1, v96
    v_cmp_lt_i32 vcc, v96, v97
    s_and_b64 exec, exec, vcc
    v_lshlrev_b32 v99, 4, v96
    v_add_u32 v99, 69632, v99
    ds_write_b128 v99, v[92:95]
    v_add_u32 v96, 1, v96
    s_mov_b64 exec, s[76:77]
    v_add_u32 v98, 64, v98
    s_branch K2_GLOOPB
K2_GENDB:
    s_mov_b64 exec, s[68:69]
K2_GDONEB:
K2_NOS1:
    s_waitcnt lgkmcnt(0)
    s_barrier
    s_add_u32 s67, s67, 256
    s_cmp_lt_u32 s67, s66
    s_cbranch_scc1 K2_ROUND
    s_nop 7
    s_nop 7
    v_and_b32 v1, 63, v0
    v_and_b32 v2, 15, v1
    v_lshrrev_b32 v3, 4, v1
    v_lshlrev_b32 v4, 4, v0
    s_lshl_b32 s70, s61, 9
    buffer_load_dwordx4 v[112:115], v4, s[40:43], s70 offen
    s_add_u32 s71, s70, 8192
    v_cmp_gt_u32 vcc, 128, v0
    s_and_saveexec_b64 s[68:69], vcc
    buffer_load_dwordx4 v[116:119], v4, s[40:43], s71 offen
    s_mov_b64 exec, s[68:69]
    v_cmp_gt_u32 vcc, 60, v0
    s_and_saveexec_b64 s[68:69], vcc
    s_mov_b32 s70, 0x0CCCCCCD
    v_mul_hi_u32 v9, s70, v0
    v_mul_u32_u24 v8, 20, v9
    v_sub_u32 v8, v0, v8
    v_add_u32 v12, s61, v8
    v_mul_u32_u24 v12, 6, v12
    v_lshl_add_u32 v12, v9, 1, v12
    buffer_load_ushort v13, v12, s[52:55], 0 offen
    s_mov_b64 exec, s[68:69]
    v_add_f32_dpp v64, v64, v64 row_shr:1 row_mask:0xf bank_mask:0xf bound_ctrl:0
    s_nop 1
    v_add_f32_dpp v64, v64, v64 row_shr:2 row_mask:0xf bank_mask:0xf bound_ctrl:0
    s_nop 1
    v_add_f32_dpp v64, v64, v64 row_shr:4 row_mask:0xf bank_mask:0xf bound_ctrl:0
    s_nop 1
    v_add_f32_dpp v64, v64, v64 row_shr:8 row_mask:0xf bank_mask:0xf bound_ctrl:0
    v_add_f32_dpp v65, v65, v65 row_shr:1 row_mask:0xf bank_mask:0xf bound_ctrl:0
    s_nop 1
    v_add_f32_dpp v65, v65, v65 row_shr:2 row_mask:0xf bank_mask:0xf bound_ctrl:0
    s_nop 1
    v_add_f32_dpp v65, v65, v65 row_shr:4 row_mask:0xf bank_mask:0xf bound_ctrl:0
    s_nop 1
    v_add_f32_dpp v65, v65, v65 row_shr:8 row_mask:0xf bank_mask:0xf bound_ctrl:0
    v_add_f32_dpp v66, v66, v66 row_shr:1 row_mask:0xf bank_mask:0xf bound_ctrl:0
    s_nop 1
    v_add_f32_dpp v66, v66, v66 row_shr:2 row_mask:0xf bank_mask:0xf bound_ctrl:0
    s_nop 1
    v_add_f32_dpp v66, v66, v66 row_shr:4 row_mask:0xf bank_mask:0xf bound_ctrl:0
    s_nop 1
    v_add_f32_dpp v66, v66, v66 row_shr:8 row_mask:0xf bank_mask:0xf bound_ctrl:0
    v_add_f32_dpp v67, v67, v67 row_shr:1 row_mask:0xf bank_mask:0xf bound_ctrl:0
    s_nop 1
    v_add_f32_dpp v67, v67, v67 row_shr:2 row_mask:0xf bank_mask:0xf bound_ctrl:0
    s_nop 1
    v_add_f32_dpp v67, v67, v67 row_shr:4 row_mask:0xf bank_mask:0xf bound_ctrl:0
    s_nop 1
    v_add_f32_dpp v67, v67, v67 row_shr:8 row_mask:0xf bank_mask:0xf bound_ctrl:0
    v_add_f32_dpp v68, v68, v68 row_shr:1 row_mask:0xf bank_mask:0xf bound_ctrl:0
    s_nop 1
    v_add_f32_dpp v68, v68, v68 row_shr:2 row_mask:0xf bank_mask:0xf bound_ctrl:0
    s_nop 1
    v_add_f32_dpp v68, v68, v68 row_shr:4 row_mask:0xf bank_mask:0xf bound_ctrl:0
    s_nop 1
    v_add_f32_dpp v68, v68, v68 row_shr:8 row_mask:0xf bank_mask:0xf bound_ctrl:0
    v_add_f32_dpp v69, v69, v69 row_shr:1 row_mask:0xf bank_mask:0xf bound_ctrl:0
    s_nop 1
    v_add_f32_dpp v69, v69, v69 row_shr:2 row_mask:0xf bank_mask:0xf bound_ctrl:0
    s_nop 1
    v_add_f32_dpp v69, v69, v69 row_shr:4 row_mask:0xf bank_mask:0xf bound_ctrl:0
    s_nop 1
    v_add_f32_dpp v69, v69, v69 row_shr:8 row_mask:0xf bank_mask:0xf bound_ctrl:0
    v_add_f32_dpp v70, v70, v70 row_shr:1 row_mask:0xf bank_mask:0xf bound_ctrl:0
    s_nop 1
    v_add_f32_dpp v70, v70, v70 row_shr:2 row_mask:0xf bank_mask:0xf bound_ctrl:0
    s_nop 1
    v_add_f32_dpp v70, v70, v70 row_shr:4 row_mask:0xf bank_mask:0xf bound_ctrl:0
    s_nop 1
    v_add_f32_dpp v70, v70, v70 row_shr:8 row_mask:0xf bank_mask:0xf bound_ctrl:0
    v_add_f32_dpp v71, v71, v71 row_shr:1 row_mask:0xf bank_mask:0xf bound_ctrl:0
    s_nop 1
    v_add_f32_dpp v71, v71, v71 row_shr:2 row_mask:0xf bank_mask:0xf bound_ctrl:0
    s_nop 1
    v_add_f32_dpp v71, v71, v71 row_shr:4 row_mask:0xf bank_mask:0xf bound_ctrl:0
    s_nop 1
    v_add_f32_dpp v71, v71, v71 row_shr:8 row_mask:0xf bank_mask:0xf bound_ctrl:0
    v_add_f32_dpp v72, v72, v72 row_shr:1 row_mask:0xf bank_mask:0xf bound_ctrl:0
    s_nop 1
    v_add_f32_dpp v72, v72, v72 row_shr:2 row_mask:0xf bank_mask:0xf bound_ctrl:0
    s_nop 1
    v_add_f32_dpp v72, v72, v72 row_shr:4 row_mask:0xf bank_mask:0xf bound_ctrl:0
    s_nop 1
    v_add_f32_dpp v72, v72, v72 row_shr:8 row_mask:0xf bank_mask:0xf bound_ctrl:0
    v_add_f32_dpp v73, v73, v73 row_shr:1 row_mask:0xf bank_mask:0xf bound_ctrl:0
    s_nop 1
    v_add_f32_dpp v73, v73, v73 row_shr:2 row_mask:0xf bank_mask:0xf bound_ctrl:0
    s_nop 1
    v_add_f32_dpp v73, v73, v73 row_shr:4 row_mask:0xf bank_mask:0xf bound_ctrl:0
    s_nop 1
    v_add_f32_dpp v73, v73, v73 row_shr:8 row_mask:0xf bank_mask:0xf bound_ctrl:0
    v_add_f32_dpp v74, v74, v74 row_shr:1 row_mask:0xf bank_mask:0xf bound_ctrl:0
    s_nop 1
    v_add_f32_dpp v74, v74, v74 row_shr:2 row_mask:0xf bank_mask:0xf bound_ctrl:0
    s_nop 1
    v_add_f32_dpp v74, v74, v74 row_shr:4 row_mask:0xf bank_mask:0xf bound_ctrl:0
    s_nop 1
    v_add_f32_dpp v74, v74, v74 row_shr:8 row_mask:0xf bank_mask:0xf bound_ctrl:0
    v_add_f32_dpp v75, v75, v75 row_shr:1 row_mask:0xf bank_mask:0xf bound_ctrl:0
    s_nop 1
    v_add_f32_dpp v75, v75, v75 row_shr:2 row_mask:0xf bank_mask:0xf bound_ctrl:0
    s_nop 1
    v_add_f32_dpp v75, v75, v75 row_shr:4 row_mask:0xf bank_mask:0xf bound_ctrl:0
    s_nop 1
    v_add_f32_dpp v75, v75, v75 row_shr:8 row_mask:0xf bank_mask:0xf bound_ctrl:0
    v_add_f32_dpp v76, v76, v76 row_shr:1 row_mask:0xf bank_mask:0xf bound_ctrl:0
    s_nop 1
    v_add_f32_dpp v76, v76, v76 row_shr:2 row_mask:0xf bank_mask:0xf bound_ctrl:0
    s_nop 1
    v_add_f32_dpp v76, v76, v76 row_shr:4 row_mask:0xf bank_mask:0xf bound_ctrl:0
    s_nop 1
    v_add_f32_dpp v76, v76, v76 row_shr:8 row_mask:0xf bank_mask:0xf bound_ctrl:0
    v_add_f32_dpp v77, v77, v77 row_shr:1 row_mask:0xf bank_mask:0xf bound_ctrl:0
    s_nop 1
    v_add_f32_dpp v77, v77, v77 row_shr:2 row_mask:0xf bank_mask:0xf bound_ctrl:0
    s_nop 1
    v_add_f32_dpp v77, v77, v77 row_shr:4 row_mask:0xf bank_mask:0xf bound_ctrl:0
    s_nop 1
    v_add_f32_dpp v77, v77, v77 row_shr:8 row_mask:0xf bank_mask:0xf bound_ctrl:0
    v_add_f32_dpp v78, v78, v78 row_shr:1 row_mask:0xf bank_mask:0xf bound_ctrl:0
    s_nop 1
    v_add_f32_dpp v78, v78, v78 row_shr:2 row_mask:0xf bank_mask:0xf bound_ctrl:0
    s_nop 1
    v_add_f32_dpp v78, v78, v78 row_shr:4 row_mask:0xf bank_mask:0xf bound_ctrl:0
    s_nop 1
    v_add_f32_dpp v78, v78, v78 row_shr:8 row_mask:0xf bank_mask:0xf bound_ctrl:0
    v_add_f32_dpp v79, v79, v79 row_shr:1 row_mask:0xf bank_mask:0xf bound_ctrl:0
    s_nop 1
    v_add_f32_dpp v79, v79, v79 row_shr:2 row_mask:0xf bank_mask:0xf bound_ctrl:0
    s_nop 1
    v_add_f32_dpp v79, v79, v79 row_shr:4 row_mask:0xf bank_mask:0xf bound_ctrl:0
    s_nop 1
    v_add_f32_dpp v79, v79, v79 row_shr:8 row_mask:0xf bank_mask:0xf bound_ctrl:0
    v_mov_b32 v96, 0
    v_mov_b32 v97, 0
    v_mov_b32 v98, 0
    v_mov_b32 v99, 0
    v_lshlrev_b32 v5, 4, v0
    ds_write_b128 v5, v[96:99] offset:63808
    v_cmp_gt_u32 vcc, 268, v0
    s_and_saveexec_b64 s[68:69], vcc
    v_add_u32 v6, 8192, v5
    ds_write_b128 v6, v[96:99] offset:63808
    s_mov_b64 exec, s[68:69]
    v_lshlrev_b32 v5, 12, v3
    v_lshl_add_u32 v5, v2, 4, v5
    s_lshl_b32 s70, s62, 8
    s_mul_i32 s71, s63, 20480
    s_add_u32 s70, s70, s71
    v_add_u32 v5, s70, v5
    s_mov_b32 exec_lo, 0x80008000
    s_mov_b32 exec_hi, 0x80008000
    v_lshlrev_b32 v6, 4, v3
    s_lshl_b32 s70, s60, 8
    v_add_u32 v6, s70, v6
    ds_write_b128 v6, v[64:67] offset:40960
    ds_write_b128 v6, v[68:71] offset:41024
    ds_write_b128 v6, v[72:75] offset:41088
    ds_write_b128 v6, v[76:79] offset:41152
    s_mov_b64 exec, -1
    v_mov_b32 v80, v32
    v_mov_b32 v81, v36
    v_mov_b32 v82, v40
    v_mov_b32 v83, v44
    v_mov_b32 v84, v33
    v_mov_b32 v85, v37
    v_mov_b32 v86, v41
    v_mov_b32 v87, v45
    v_mov_b32 v88, v34
    v_mov_b32 v89, v38
    v_mov_b32 v90, v42
    v_mov_b32 v91, v46
    v_mov_b32 v92, v35
    v_mov_b32 v93, v39
    v_mov_b32 v94, v43
    v_mov_b32 v95, v47
    v_mov_b32 v96, v48
    v_mov_b32 v97, v52
    v_mov_b32 v98, v56
    v_mov_b32 v99, v60
    v_mov_b32 v100, v49
    v_mov_b32 v101, v53
    v_mov_b32 v102, v57
    v_mov_b32 v103, v61
    v_mov_b32 v104, v50
    v_mov_b32 v105, v54
    v_mov_b32 v106, v58
    v_mov_b32 v107, v62
    v_mov_b32 v108, v51
    v_mov_b32 v109, v55
    v_mov_b32 v110, v59
    v_mov_b32 v111, v63
    ds_write_b128 v5, v[80:83] offset:0
    ds_write_b128 v5, v[84:87] offset:1024
    ds_write_b128 v5, v[88:91] offset:2048
    ds_write_b128 v5, v[92:95] offset:3072
    s_mov_b64 exec, 0xffff
    ds_write_b128 v5, v[96:99] offset:16384
    ds_write_b128 v5, v[100:103] offset:17408
    ds_write_b128 v5, v[104:107] offset:18432
    ds_write_b128 v5, v[108:111] offset:19456
    s_mov_b64 exec, -1
    s_lshl_b32 s70, s60, 5
    v_add_u32 v4, s70, v2
    v_lshlrev_b32 v4, 10, v4
    v_lshl_add_u32 v4, v3, 4, v4
    buffer_load_dwordx4 v[16:19], v4, s[48:51], 0 offen offset:0
    buffer_load_dwordx4 v[20:23], v4, s[48:51], 0 offen offset:64
    buffer_load_dwordx4 v[24:27], v4, s[48:51], 0 offen offset:128
    buffer_load_dwordx4 v[28:31], v4, s[48:51], 0 offen offset:192
    buffer_load_dwordx4 v[32:35], v4, s[48:51], 0 offen offset:256
    buffer_load_dwordx4 v[36:39], v4, s[48:51], 0 offen offset:320
    buffer_load_dwordx4 v[40:43], v4, s[48:51], 0 offen offset:384
    buffer_load_dwordx4 v[44:47], v4, s[48:51], 0 offen offset:448
    buffer_load_dwordx4 v[48:51], v4, s[48:51], 0 offen offset:512
    buffer_load_dwordx4 v[52:55], v4, s[48:51], 0 offen offset:576
    buffer_load_dwordx4 v[56:59], v4, s[48:51], 0 offen offset:640
    buffer_load_dwordx4 v[60:63], v4, s[48:51], 0 offen offset:704
    buffer_load_dwordx4 v[64:67], v4, s[48:51], 0 offen offset:768
    buffer_load_dwordx4 v[68:71], v4, s[48:51], 0 offen offset:832
    buffer_load_dwordx4 v[72:75], v4, s[48:51], 0 offen offset:896
    buffer_load_dwordx4 v[76:79], v4, s[48:51], 0 offen offset:960
    v_add_u32 v120, 16384, v4
    v_lshrrev_b32 v5, 5, v0
    v_and_b32 v6, 31, v0
    v_mul_u32_u24 v7, 1040, v5
    v_lshl_add_u32 v7, v6, 4, v7
    v_add_u32 v7, 43008, v7
    s_waitcnt vmcnt(17)
    ds_write_b128 v7, v[112:115]
    v_cmp_gt_u32 vcc, 128, v0
    s_and_saveexec_b64 s[68:69], vcc
    ds_write_b128 v7, v[116:119] offset:16640
    s_mov_b64 exec, s[68:69]
    s_waitcnt lgkmcnt(0)
    s_barrier
    s_mov_b32 s70, 0xbf317218
    v_lshlrev_b32 v8, 10, v5
    v_lshl_add_u32 v8, v6, 5, v8
    ds_read_b128 v[96:99], v8 offset:0
    ds_read_b128 v[100:103], v8 offset:16
    ds_read_b128 v[104:107], v8 offset:20480
    ds_read_b128 v[108:111], v8 offset:20496
    s_waitcnt lgkmcnt(0)
    v_add_f32 v96, v96, v104
    v_add_f32 v97, v97, v105
    v_add_f32 v98, v98, v106
    v_add_f32 v99, v99, v107
    v_add_f32 v100, v100, v108
    v_add_f32 v101, v101, v109
    v_add_f32 v102, v102, v110
    v_add_f32 v103, v103, v111
    v_mul_f32 v96, s70, v96
    v_mul_f32 v97, s70, v97
    v_mul_f32 v98, s70, v98
    v_mul_f32 v99, s70, v99
    v_mul_f32 v100, s70, v100
    v_mul_f32 v101, s70, v101
    v_mul_f32 v102, s70, v102
    v_mul_f32 v103, s70, v103
    v_cvt_pk_bf16_f32 v104, v96, v97
    v_cvt_pk_bf16_f32 v105, v98, v99
    v_cvt_pk_bf16_f32 v106, v100, v101
    v_cvt_pk_bf16_f32 v107, v102, v103
    ds_write_b128 v7, v[104:107] offset:512
    v_cmp_gt_u32 vcc, 128, v0
    s_and_saveexec_b64 s[68:69], vcc
    v_lshlrev_b32 v8, 10, v5
    v_lshl_add_u32 v8, v6, 5, v8
    ds_read_b128 v[96:99], v8 offset:16384
    ds_read_b128 v[100:103], v8 offset:16400
    ds_read_b128 v[104:107], v8 offset:36864
    ds_read_b128 v[108:111], v8 offset:36880
    s_waitcnt lgkmcnt(0)
    v_add_f32 v96, v96, v104
    v_add_f32 v97, v97, v105
    v_add_f32 v98, v98, v106
    v_add_f32 v99, v99, v107
    v_add_f32 v100, v100, v108
    v_add_f32 v101, v101, v109
    v_add_f32 v102, v102, v110
    v_add_f32 v103, v103, v111
    v_mul_f32 v96, s70, v96
    v_mul_f32 v97, s70, v97
    v_mul_f32 v98, s70, v98
    v_mul_f32 v99, s70, v99
    v_mul_f32 v100, s70, v100
    v_mul_f32 v101, s70, v101
    v_mul_f32 v102, s70, v102
    v_mul_f32 v103, s70, v103
    v_cvt_pk_bf16_f32 v104, v96, v97
    v_cvt_pk_bf16_f32 v105, v98, v99
    v_cvt_pk_bf16_f32 v106, v100, v101
    v_cvt_pk_bf16_f32 v107, v102, v103
    ds_write_b128 v7, v[104:107] offset:17152
    s_mov_b64 exec, s[68:69]
    v_cmp_gt_u32 vcc, 60, v0
    s_and_saveexec_b64 s[68:69], vcc
    v_lshlrev_b32 v10, 2, v0
    ds_read_b32 v100, v10 offset:40960
    ds_read_b32 v101, v10 offset:41216
    ds_read_b32 v102, v10 offset:41472
    ds_read_b32 v103, v10 offset:41728
    ds_read_b32 v104, v10 offset:41984
    ds_read_b32 v105, v10 offset:42240
    ds_read_b32 v106, v10 offset:42496
    ds_read_b32 v107, v10 offset:42752
    s_waitcnt vmcnt(16) lgkmcnt(0)
    v_add_f32 v100, v100, v101
    v_add_f32 v100, v100, v102
    v_add_f32 v100, v100, v103
    v_add_f32 v100, v100, v104
    v_add_f32 v100, v100, v105
    v_add_f32 v100, v100, v106
    v_add_f32 v100, v100, v107
    v_lshlrev_b32 v13, 16, v13
    v_add_f32 v13, v13, v100
    v_cvt_pk_bf16_f32 v13, v13, v13
    s_mov_b32 s70, 5120000
    buffer_store_short v13, v12, s[44:47], s70 offen
    s_mov_b64 exec, s[68:69]
    s_waitcnt lgkmcnt(0)
    s_barrier
    v_mul_u32_u24 v5, 1040, v2
    v_lshl_add_u32 v5, v3, 4, v5
    v_add_u32 v5, 43008, v5
    ds_read_b128 v[96:99], v5 offset:0
    ds_read_b128 v[100:103], v5 offset:64
    ds_read_b128 v[104:107], v5 offset:128
    ds_read_b128 v[108:111], v5 offset:192
    s_waitcnt vmcnt(15) lgkmcnt(3)
    v_mfma_f32_16x16x32_bf16 v[80:83], v[16:19], v[96:99], 0
    s_waitcnt vmcnt(14) lgkmcnt(2)
    v_mfma_f32_16x16x32_bf16 v[80:83], v[20:23], v[100:103], v[80:83]
    s_waitcnt vmcnt(13) lgkmcnt(1)
    v_mfma_f32_16x16x32_bf16 v[80:83], v[24:27], v[104:107], v[80:83]
    s_waitcnt vmcnt(12) lgkmcnt(0)
    v_mfma_f32_16x16x32_bf16 v[80:83], v[28:31], v[108:111], v[80:83]
    ds_read_b128 v[96:99], v5 offset:256
    ds_read_b128 v[100:103], v5 offset:320
    ds_read_b128 v[104:107], v5 offset:384
    ds_read_b128 v[108:111], v5 offset:448
    s_waitcnt vmcnt(11) lgkmcnt(3)
    v_mfma_f32_16x16x32_bf16 v[80:83], v[32:35], v[96:99], v[80:83]
    s_waitcnt vmcnt(10) lgkmcnt(2)
    v_mfma_f32_16x16x32_bf16 v[80:83], v[36:39], v[100:103], v[80:83]
    s_waitcnt vmcnt(9) lgkmcnt(1)
    v_mfma_f32_16x16x32_bf16 v[80:83], v[40:43], v[104:107], v[80:83]
    s_waitcnt vmcnt(8) lgkmcnt(0)
    v_mfma_f32_16x16x32_bf16 v[80:83], v[44:47], v[108:111], v[80:83]
    ds_read_b128 v[96:99], v5 offset:512
    ds_read_b128 v[100:103], v5 offset:576
    ds_read_b128 v[104:107], v5 offset:640
    ds_read_b128 v[108:111], v5 offset:704
    s_waitcnt vmcnt(7) lgkmcnt(3)
    v_mfma_f32_16x16x32_bf16 v[80:83], v[48:51], v[96:99], v[80:83]
    s_waitcnt vmcnt(6) lgkmcnt(2)
    v_mfma_f32_16x16x32_bf16 v[80:83], v[52:55], v[100:103], v[80:83]
    s_waitcnt vmcnt(5) lgkmcnt(1)
    v_mfma_f32_16x16x32_bf16 v[80:83], v[56:59], v[104:107], v[80:83]
    s_waitcnt vmcnt(4) lgkmcnt(0)
    v_mfma_f32_16x16x32_bf16 v[80:83], v[60:63], v[108:111], v[80:83]
    ds_read_b128 v[96:99], v5 offset:768
    ds_read_b128 v[100:103], v5 offset:832
    ds_read_b128 v[104:107], v5 offset:896
    ds_read_b128 v[108:111], v5 offset:960
    s_waitcnt vmcnt(3) lgkmcnt(3)
    v_mfma_f32_16x16x32_bf16 v[80:83], v[64:67], v[96:99], v[80:83]
    s_waitcnt vmcnt(2) lgkmcnt(2)
    v_mfma_f32_16x16x32_bf16 v[80:83], v[68:71], v[100:103], v[80:83]
    s_waitcnt vmcnt(1) lgkmcnt(1)
    v_mfma_f32_16x16x32_bf16 v[80:83], v[72:75], v[104:107], v[80:83]
    s_waitcnt vmcnt(0) lgkmcnt(0)
    v_mfma_f32_16x16x32_bf16 v[80:83], v[76:79], v[108:111], v[80:83]
    ds_read_b128 v[96:99], v5 offset:16640
    ds_read_b128 v[100:103], v5 offset:16704
    ds_read_b128 v[104:107], v5 offset:16768
    ds_read_b128 v[108:111], v5 offset:16832
    s_waitcnt lgkmcnt(3)
    v_mfma_f32_16x16x32_bf16 v[84:87], v[16:19], v[96:99], 0
    s_waitcnt lgkmcnt(2)
    v_mfma_f32_16x16x32_bf16 v[84:87], v[20:23], v[100:103], v[84:87]
    s_waitcnt lgkmcnt(1)
    v_mfma_f32_16x16x32_bf16 v[84:87], v[24:27], v[104:107], v[84:87]
    s_waitcnt lgkmcnt(0)
    v_mfma_f32_16x16x32_bf16 v[84:87], v[28:31], v[108:111], v[84:87]
    s_nop 7
    buffer_load_dwordx4 v[16:19], v120, s[48:51], 0 offen offset:0
    buffer_load_dwordx4 v[20:23], v120, s[48:51], 0 offen offset:64
    buffer_load_dwordx4 v[24:27], v120, s[48:51], 0 offen offset:128
    buffer_load_dwordx4 v[28:31], v120, s[48:51], 0 offen offset:192
    ds_read_b128 v[96:99], v5 offset:16896
    ds_read_b128 v[100:103], v5 offset:16960
    ds_read_b128 v[104:107], v5 offset:17024
    ds_read_b128 v[108:111], v5 offset:17088
    s_waitcnt lgkmcnt(3)
    v_mfma_f32_16x16x32_bf16 v[84:87], v[32:35], v[96:99], v[84:87]
    s_waitcnt lgkmcnt(2)
    v_mfma_f32_16x16x32_bf16 v[84:87], v[36:39], v[100:103], v[84:87]
    s_waitcnt lgkmcnt(1)
    v_mfma_f32_16x16x32_bf16 v[84:87], v[40:43], v[104:107], v[84:87]
    s_waitcnt lgkmcnt(0)
    v_mfma_f32_16x16x32_bf16 v[84:87], v[44:47], v[108:111], v[84:87]
    s_nop 7
    buffer_load_dwordx4 v[32:35], v120, s[48:51], 0 offen offset:256
    buffer_load_dwordx4 v[36:39], v120, s[48:51], 0 offen offset:320
    buffer_load_dwordx4 v[40:43], v120, s[48:51], 0 offen offset:384
    buffer_load_dwordx4 v[44:47], v120, s[48:51], 0 offen offset:448
    ds_read_b128 v[96:99], v5 offset:17152
    ds_read_b128 v[100:103], v5 offset:17216
    ds_read_b128 v[104:107], v5 offset:17280
    ds_read_b128 v[108:111], v5 offset:17344
    s_waitcnt lgkmcnt(3)
    v_mfma_f32_16x16x32_bf16 v[84:87], v[48:51], v[96:99], v[84:87]
    s_waitcnt lgkmcnt(2)
    v_mfma_f32_16x16x32_bf16 v[84:87], v[52:55], v[100:103], v[84:87]
    s_waitcnt lgkmcnt(1)
    v_mfma_f32_16x16x32_bf16 v[84:87], v[56:59], v[104:107], v[84:87]
    s_waitcnt lgkmcnt(0)
    v_mfma_f32_16x16x32_bf16 v[84:87], v[60:63], v[108:111], v[84:87]
    s_nop 7
    buffer_load_dwordx4 v[48:51], v120, s[48:51], 0 offen offset:512
    buffer_load_dwordx4 v[52:55], v120, s[48:51], 0 offen offset:576
    buffer_load_dwordx4 v[56:59], v120, s[48:51], 0 offen offset:640
    buffer_load_dwordx4 v[60:63], v120, s[48:51], 0 offen offset:704
    ds_read_b128 v[96:99], v5 offset:17408
    ds_read_b128 v[100:103], v5 offset:17472
    ds_read_b128 v[104:107], v5 offset:17536
    ds_read_b128 v[108:111], v5 offset:17600
    s_waitcnt lgkmcnt(3)
    v_mfma_f32_16x16x32_bf16 v[84:87], v[64:67], v[96:99], v[84:87]
    s_waitcnt lgkmcnt(2)
    v_mfma_f32_16x16x32_bf16 v[84:87], v[68:71], v[100:103], v[84:87]
    s_waitcnt lgkmcnt(1)
    v_mfma_f32_16x16x32_bf16 v[84:87], v[72:75], v[104:107], v[84:87]
    s_waitcnt lgkmcnt(0)
    v_mfma_f32_16x16x32_bf16 v[84:87], v[76:79], v[108:111], v[84:87]
    s_nop 7
    buffer_load_dwordx4 v[64:67], v120, s[48:51], 0 offen offset:768
    buffer_load_dwordx4 v[68:71], v120, s[48:51], 0 offen offset:832
    buffer_load_dwordx4 v[72:75], v120, s[48:51], 0 offen offset:896
    buffer_load_dwordx4 v[76:79], v120, s[48:51], 0 offen offset:960
    s_mov_b32 s70, 0xbfb8aa3b
    s_lshl_b32 s71, s60, 6
    s_add_u32 s71, s71, 0
    v_lshlrev_b32 v6, 3, v3
    v_add_u32 v6, s71, v6
    v_add_u32 v7, 0, v2
    v_mul_u32_u24 v8, 1040, v7
    v_add_u32 v8, v8, v6
    ds_read_b64 v[10:11], v8 offset:43008
    v_mul_f32 v96, s70, v80
    v_mul_f32 v97, s70, v81
    v_mul_f32 v98, s70, v82
    v_mul_f32 v99, s70, v83
    v_exp_f32 v96, v96
    v_exp_f32 v97, v97
    v_exp_f32 v98, v98
    v_exp_f32 v99, v99
    v_add_f32 v96, 1.0, v96
    v_add_f32 v97, 1.0, v97
    v_add_f32 v98, 1.0, v98
    v_add_f32 v99, 1.0, v99
    v_rcp_f32 v96, v96
    v_rcp_f32 v97, v97
    v_rcp_f32 v98, v98
    v_rcp_f32 v99, v99
    v_mul_f32 v96, v96, v80
    v_mul_f32 v97, v97, v81
    v_mul_f32 v98, v98, v82
    v_mul_f32 v99, v99, v83
    s_waitcnt lgkmcnt(0)
    v_lshlrev_b32 v100, 16, v10
    v_and_b32 v101, 0xffff0000, v10
    v_lshlrev_b32 v102, 16, v11
    v_and_b32 v103, 0xffff0000, v11
    v_add_f32 v96, v96, v100
    v_add_f32 v97, v97, v101
    v_add_f32 v98, v98, v102
    v_add_f32 v99, v99, v103
    v_cvt_pk_bf16_f32 v122, v96, v97
    v_cvt_pk_bf16_f32 v123, v98, v99
    v_add_u32 v9, s61, v7
    v_lshlrev_b32 v9, 9, v9
    v_add_u32 v9, v9, v6
    v_cmp_gt_u32 vcc, 20, v7
    s_and_saveexec_b64 s[68:69], vcc
    buffer_store_dwordx2 v[122:123], v9, s[44:47], 0 offen
    s_mov_b64 exec, s[68:69]
    v_add_u32 v7, 16, v2
    v_mul_u32_u24 v8, 1040, v7
    v_add_u32 v8, v8, v6
    ds_read_b64 v[10:11], v8 offset:43008
    v_mul_f32 v96, s70, v84
    v_mul_f32 v97, s70, v85
    v_mul_f32 v98, s70, v86
    v_mul_f32 v99, s70, v87
    v_exp_f32 v96, v96
    v_exp_f32 v97, v97
    v_exp_f32 v98, v98
    v_exp_f32 v99, v99
    v_add_f32 v96, 1.0, v96
    v_add_f32 v97, 1.0, v97
    v_add_f32 v98, 1.0, v98
    v_add_f32 v99, 1.0, v99
    v_rcp_f32 v96, v96
    v_rcp_f32 v97, v97
    v_rcp_f32 v98, v98
    v_rcp_f32 v99, v99
    v_mul_f32 v96, v96, v84
    v_mul_f32 v97, v97, v85
    v_mul_f32 v98, v98, v86
    v_mul_f32 v99, v99, v87
    s_waitcnt lgkmcnt(0)
    v_lshlrev_b32 v100, 16, v10
    v_and_b32 v101, 0xffff0000, v10
    v_lshlrev_b32 v102, 16, v11
    v_and_b32 v103, 0xffff0000, v11
    v_add_f32 v96, v96, v100
    v_add_f32 v97, v97, v101
    v_add_f32 v98, v98, v102
    v_add_f32 v99, v99, v103
    v_cvt_pk_bf16_f32 v124, v96, v97
    v_cvt_pk_bf16_f32 v125, v98, v99
    v_add_u32 v9, s61, v7
    v_lshlrev_b32 v9, 9, v9
    v_add_u32 v9, v9, v6
    v_cmp_gt_u32 vcc, 20, v7
    s_and_saveexec_b64 s[68:69], vcc
    buffer_store_dwordx2 v[124:125], v9, s[44:47], 0 offen
    s_mov_b64 exec, s[68:69]
    ds_read_b128 v[96:99], v5 offset:0
    ds_read_b128 v[100:103], v5 offset:64
    ds_read_b128 v[104:107], v5 offset:128
    ds_read_b128 v[108:111], v5 offset:192
    s_waitcnt vmcnt(15) lgkmcnt(3)
    v_mfma_f32_16x16x32_bf16 v[80:83], v[16:19], v[96:99], 0
    s_waitcnt vmcnt(14) lgkmcnt(2)
    v_mfma_f32_16x16x32_bf16 v[80:83], v[20:23], v[100:103], v[80:83]
    s_waitcnt vmcnt(13) lgkmcnt(1)
    v_mfma_f32_16x16x32_bf16 v[80:83], v[24:27], v[104:107], v[80:83]
    s_waitcnt vmcnt(12) lgkmcnt(0)
    v_mfma_f32_16x16x32_bf16 v[80:83], v[28:31], v[108:111], v[80:83]
    ds_read_b128 v[96:99], v5 offset:256
    ds_read_b128 v[100:103], v5 offset:320
    ds_read_b128 v[104:107], v5 offset:384
    ds_read_b128 v[108:111], v5 offset:448
    s_waitcnt vmcnt(11) lgkmcnt(3)
    v_mfma_f32_16x16x32_bf16 v[80:83], v[32:35], v[96:99], v[80:83]
    s_waitcnt vmcnt(10) lgkmcnt(2)
    v_mfma_f32_16x16x32_bf16 v[80:83], v[36:39], v[100:103], v[80:83]
    s_waitcnt vmcnt(9) lgkmcnt(1)
    v_mfma_f32_16x16x32_bf16 v[80:83], v[40:43], v[104:107], v[80:83]
    s_waitcnt vmcnt(8) lgkmcnt(0)
    v_mfma_f32_16x16x32_bf16 v[80:83], v[44:47], v[108:111], v[80:83]
    ds_read_b128 v[96:99], v5 offset:512
    ds_read_b128 v[100:103], v5 offset:576
    ds_read_b128 v[104:107], v5 offset:640
    ds_read_b128 v[108:111], v5 offset:704
    s_waitcnt vmcnt(7) lgkmcnt(3)
    v_mfma_f32_16x16x32_bf16 v[80:83], v[48:51], v[96:99], v[80:83]
    s_waitcnt vmcnt(6) lgkmcnt(2)
    v_mfma_f32_16x16x32_bf16 v[80:83], v[52:55], v[100:103], v[80:83]
    s_waitcnt vmcnt(5) lgkmcnt(1)
    v_mfma_f32_16x16x32_bf16 v[80:83], v[56:59], v[104:107], v[80:83]
    s_waitcnt vmcnt(4) lgkmcnt(0)
    v_mfma_f32_16x16x32_bf16 v[80:83], v[60:63], v[108:111], v[80:83]
    ds_read_b128 v[96:99], v5 offset:768
    ds_read_b128 v[100:103], v5 offset:832
    ds_read_b128 v[104:107], v5 offset:896
    ds_read_b128 v[108:111], v5 offset:960
    s_waitcnt vmcnt(3) lgkmcnt(3)
    v_mfma_f32_16x16x32_bf16 v[80:83], v[64:67], v[96:99], v[80:83]
    s_waitcnt vmcnt(2) lgkmcnt(2)
    v_mfma_f32_16x16x32_bf16 v[80:83], v[68:71], v[100:103], v[80:83]
    s_waitcnt vmcnt(1) lgkmcnt(1)
    v_mfma_f32_16x16x32_bf16 v[80:83], v[72:75], v[104:107], v[80:83]
    s_waitcnt vmcnt(0) lgkmcnt(0)
    v_mfma_f32_16x16x32_bf16 v[80:83], v[76:79], v[108:111], v[80:83]
    ds_read_b128 v[96:99], v5 offset:16640
    ds_read_b128 v[100:103], v5 offset:16704
    ds_read_b128 v[104:107], v5 offset:16768
    ds_read_b128 v[108:111], v5 offset:16832
    s_waitcnt lgkmcnt(3)
    v_mfma_f32_16x16x32_bf16 v[84:87], v[16:19], v[96:99], 0
    s_waitcnt lgkmcnt(2)
    v_mfma_f32_16x16x32_bf16 v[84:87], v[20:23], v[100:103], v[84:87]
    s_waitcnt lgkmcnt(1)
    v_mfma_f32_16x16x32_bf16 v[84:87], v[24:27], v[104:107], v[84:87]
    s_waitcnt lgkmcnt(0)
    v_mfma_f32_16x16x32_bf16 v[84:87], v[28:31], v[108:111], v[84:87]
    ds_read_b128 v[96:99], v5 offset:16896
    ds_read_b128 v[100:103], v5 offset:16960
    ds_read_b128 v[104:107], v5 offset:17024
    ds_read_b128 v[108:111], v5 offset:17088
    s_waitcnt lgkmcnt(3)
    v_mfma_f32_16x16x32_bf16 v[84:87], v[32:35], v[96:99], v[84:87]
    s_waitcnt lgkmcnt(2)
    v_mfma_f32_16x16x32_bf16 v[84:87], v[36:39], v[100:103], v[84:87]
    s_waitcnt lgkmcnt(1)
    v_mfma_f32_16x16x32_bf16 v[84:87], v[40:43], v[104:107], v[84:87]
    s_waitcnt lgkmcnt(0)
    v_mfma_f32_16x16x32_bf16 v[84:87], v[44:47], v[108:111], v[84:87]
    ds_read_b128 v[96:99], v5 offset:17152
    ds_read_b128 v[100:103], v5 offset:17216
    ds_read_b128 v[104:107], v5 offset:17280
    ds_read_b128 v[108:111], v5 offset:17344
    s_waitcnt lgkmcnt(3)
    v_mfma_f32_16x16x32_bf16 v[84:87], v[48:51], v[96:99], v[84:87]
    s_waitcnt lgkmcnt(2)
    v_mfma_f32_16x16x32_bf16 v[84:87], v[52:55], v[100:103], v[84:87]
    s_waitcnt lgkmcnt(1)
    v_mfma_f32_16x16x32_bf16 v[84:87], v[56:59], v[104:107], v[84:87]
    s_waitcnt lgkmcnt(0)
    v_mfma_f32_16x16x32_bf16 v[84:87], v[60:63], v[108:111], v[84:87]
    ds_read_b128 v[96:99], v5 offset:17408
    ds_read_b128 v[100:103], v5 offset:17472
    ds_read_b128 v[104:107], v5 offset:17536
    ds_read_b128 v[108:111], v5 offset:17600
    s_waitcnt lgkmcnt(3)
    v_mfma_f32_16x16x32_bf16 v[84:87], v[64:67], v[96:99], v[84:87]
    s_waitcnt lgkmcnt(2)
    v_mfma_f32_16x16x32_bf16 v[84:87], v[68:71], v[100:103], v[84:87]
    s_waitcnt lgkmcnt(1)
    v_mfma_f32_16x16x32_bf16 v[84:87], v[72:75], v[104:107], v[84:87]
    s_waitcnt lgkmcnt(0)
    v_mfma_f32_16x16x32_bf16 v[84:87], v[76:79], v[108:111], v[84:87]
    s_mov_b32 s70, 0xbfb8aa3b
    s_lshl_b32 s71, s60, 6
    s_add_u32 s71, s71, 32
    v_lshlrev_b32 v6, 3, v3
    v_add_u32 v6, s71, v6
    v_add_u32 v7, 0, v2
    v_mul_u32_u24 v8, 1040, v7
    v_add_u32 v8, v8, v6
    ds_read_b64 v[10:11], v8 offset:43008
    v_mul_f32 v96, s70, v80
    v_mul_f32 v97, s70, v81
    v_mul_f32 v98, s70, v82
    v_mul_f32 v99, s70, v83
    v_exp_f32 v96, v96
    v_exp_f32 v97, v97
    v_exp_f32 v98, v98
    v_exp_f32 v99, v99
    v_add_f32 v96, 1.0, v96
    v_add_f32 v97, 1.0, v97
    v_add_f32 v98, 1.0, v98
    v_add_f32 v99, 1.0, v99
    v_rcp_f32 v96, v96
    v_rcp_f32 v97, v97
    v_rcp_f32 v98, v98
    v_rcp_f32 v99, v99
    v_mul_f32 v96, v96, v80
    v_mul_f32 v97, v97, v81
    v_mul_f32 v98, v98, v82
    v_mul_f32 v99, v99, v83
    s_waitcnt lgkmcnt(0)
    v_lshlrev_b32 v100, 16, v10
    v_and_b32 v101, 0xffff0000, v10
    v_lshlrev_b32 v102, 16, v11
    v_and_b32 v103, 0xffff0000, v11
    v_add_f32 v96, v96, v100
    v_add_f32 v97, v97, v101
    v_add_f32 v98, v98, v102
    v_add_f32 v99, v99, v103
    v_cvt_pk_bf16_f32 v122, v96, v97
    v_cvt_pk_bf16_f32 v123, v98, v99
    v_add_u32 v9, s61, v7
    v_lshlrev_b32 v9, 9, v9
    v_add_u32 v9, v9, v6
    v_cmp_gt_u32 vcc, 20, v7
    s_and_saveexec_b64 s[68:69], vcc
    buffer_store_dwordx2 v[122:123], v9, s[44:47], 0 offen
    s_mov_b64 exec, s[68:69]
    v_add_u32 v7, 16, v2
    v_mul_u32_u24 v8, 1040, v7
    v_add_u32 v8, v8, v6
    ds_read_b64 v[10:11], v8 offset:43008
    v_mul_f32 v96, s70, v84
    v_mul_f32 v97, s70, v85
    v_mul_f32 v98, s70, v86
    v_mul_f32 v99, s70, v87
    v_exp_f32 v96, v96
    v_exp_f32 v97, v97
    v_exp_f32 v98, v98
    v_exp_f32 v99, v99
    v_add_f32 v96, 1.0, v96
    v_add_f32 v97, 1.0, v97
    v_add_f32 v98, 1.0, v98
    v_add_f32 v99, 1.0, v99
    v_rcp_f32 v96, v96
    v_rcp_f32 v97, v97
    v_rcp_f32 v98, v98
    v_rcp_f32 v99, v99
    v_mul_f32 v96, v96, v84
    v_mul_f32 v97, v97, v85
    v_mul_f32 v98, v98, v86
    v_mul_f32 v99, v99, v87
    s_waitcnt lgkmcnt(0)
    v_lshlrev_b32 v100, 16, v10
    v_and_b32 v101, 0xffff0000, v10
    v_lshlrev_b32 v102, 16, v11
    v_and_b32 v103, 0xffff0000, v11
    v_add_f32 v96, v96, v100
    v_add_f32 v97, v97, v101
    v_add_f32 v98, v98, v102
    v_add_f32 v99, v99, v103
    v_cvt_pk_bf16_f32 v124, v96, v97
    v_cvt_pk_bf16_f32 v125, v98, v99
    v_add_u32 v9, s61, v7
    v_lshlrev_b32 v9, 9, v9
    v_add_u32 v9, v9, v6
    v_cmp_gt_u32 vcc, 20, v7
    s_and_saveexec_b64 s[68:69], vcc
    buffer_store_dwordx2 v[124:125], v9, s[44:47], 0 offen
    s_mov_b64 exec, s[68:69]
K2_END:
    s_endpgm
.section .rodata,"a"
.p2align 6
.amdhsa_kernel egnn_prep_kernel
  .amdhsa_next_free_vgpr 112
  .amdhsa_next_free_sgpr 102
  .amdhsa_accum_offset 112
  .amdhsa_group_segment_fixed_size 0
  .amdhsa_kernarg_size 88
  .amdhsa_user_sgpr_count 2
  .amdhsa_user_sgpr_kernarg_segment_ptr 1
  .amdhsa_system_sgpr_workgroup_id_x 1
.end_amdhsa_kernel
.text
.section .rodata,"a"
.p2align 6
.amdhsa_kernel gather_scatter__cheap_equivariant_egnn__graph_kernel
  .amdhsa_next_free_vgpr 128
  .amdhsa_next_free_sgpr 102
  .amdhsa_accum_offset 128
  .amdhsa_group_segment_fixed_size 0
  .amdhsa_kernarg_size 88
  .amdhsa_user_sgpr_count 2
  .amdhsa_user_sgpr_kernarg_segment_ptr 1
  .amdhsa_system_sgpr_workgroup_id_x 1
.end_amdhsa_kernel
.text
```
